```python
import torch

def _softmax(x, axis=-1):
    return torch.softmax(x, dim=axis)
def _gelu(x):
    return torch.nn.functional.gelu(x, approximate="tanh")
def _silu(x):
    return torch.nn.functional.silu(x)
def _sigmoid(x):
    return torch.sigmoid(x)
def _layernorm(x, axis=-1, eps=1e-5):
    m = x.mean(dim=axis, keepdim=True)
    v = x.var(dim=axis, keepdim=True, unbiased=False)
    return (x - m) / torch.sqrt(v + eps)
def _scatter_add(tgt, idx, src, axis=0):
    return tgt.clone().index_add_(axis, idx, src)
def _segment_sum(src, seg, n):
    out = torch.zeros((n,) + src.shape[1:], dtype=src.dtype)
    return out.index_add_(0, seg, src)
def _pad(x, pw):
    flat = tuple(v for pair in reversed(pw) for v in pair)
    return torch.nn.functional.pad(x, flat)

kernel_name = 'parallel_sum__mha_block_cached__swiglu_ffn__decode'

def setup_inputs():

    _w = (lambda a: (lambda t: t.to(torch.bfloat16) if t.is_floating_point() else t)(torch.as_tensor(a)))
    def _A_setup():
        B, Sq, D = 2, 1, 640
        H, Sk, Dh = 32, 4096, 192
        return {
            "x": _w((lambda *s: torch.randn(*s, dtype=torch.bfloat16) * 0.05)(B, Sq, D)),
            "k_cache": _w((lambda *s: torch.randn(*s, dtype=torch.bfloat16) * 3.2)(B, H, Sk, Dh)),
            "v_cache": _w((lambda *s: torch.randn(*s, dtype=torch.bfloat16) * 1.6)(B, H, Sk, Dh)),
            "wq": _w((lambda *s: torch.randn(*s, dtype=torch.bfloat16) * 3.2)(D, H * Dh) * (D ** -0.5)),
            "wo": _w((lambda *s: torch.randn(*s, dtype=torch.bfloat16) * 1.6)(H * Dh, D) * ((H * Dh) ** -0.5)),
        }
    _A_in = _A_setup()

    def _B_setup():
        B, S, D, F = 2, 1, 640, 1536
        return {
            "x": _w((lambda *s: torch.randn(*s, dtype=torch.bfloat16) * 0.05)(B, S, D)),
            "w_gate": _w((lambda *s: torch.randn(*s, dtype=torch.bfloat16) * 0.05)(D, F)),
            "w_up": _w((lambda *s: torch.randn(*s, dtype=torch.bfloat16) * 0.05)(D, F)),
            "w_down": _w((lambda *s: torch.randn(*s, dtype=torch.bfloat16) * 0.05)(F, D)),
        }
    _B_in = _B_setup()

    return {
        "A_x": _A_in["x"],
        "A_k_cache": _A_in["k_cache"],
        "A_v_cache": _A_in["v_cache"],
        "A_wq": _A_in["wq"],
        "A_wo": _A_in["wo"],
        "B_x": _B_in["x"],
        "B_w_gate": _B_in["w_gate"],
        "B_w_up": _B_in["w_up"],
        "B_w_down": _B_in["w_down"],
    }

def reference(A_x, A_k_cache, A_v_cache, A_wq, A_wo, B_x, B_w_gate, B_w_up, B_w_down):
    def _A_ref(x, k_cache, v_cache, wq, wo):
        B, Sq, D = x.shape
        H, Dh = 32, 192
        q = (lambda x, *d: x.permute(*d))((x @ wq).reshape(B, Sq, H, Dh), 0, 2, 1, 3)
        scores = torch.einsum("bhqd,bhkd->bhqk", q, k_cache) * (Dh ** -0.5)
        p = _softmax(scores, axis=-1)
        o = torch.einsum("bhqk,bhkd->bhqd", p, v_cache)
        return (lambda x, *d: x.permute(*d))(o, 0, 2, 1, 3).reshape(B, Sq, H * Dh) @ wo

    def _B_ref(x, w_gate, w_up, w_down):
        g = _silu(x @ w_gate)
        u = x @ w_up
        return (g * u) @ w_down

    x = A_x
    xn = _layernorm(x, axis=-1)
    return x + _A_ref(xn, A_k_cache, A_v_cache, A_wq, A_wo) + _B_ref(xn, B_w_gate, B_w_up, B_w_down)
```

```asm
; @launch grid=(256,1,1) block=(512,1,1) lds=92672
.amdgcn_target "amdgcn-amd-amdhsa--gfx950"
.text
.globl parallel_sum__mha_block_cached__swiglu_ffn__decode_kernel
.p2align 8
.type parallel_sum__mha_block_cached__swiglu_ffn__decode_kernel,@function
parallel_sum__mha_block_cached__swiglu_ffn__decode_kernel:
s_load_dwordx16 s[4:19], s[0:1], 0
s_load_dwordx8 s[20:27], s[0:1], 64
s_cmp_ge_u32 s2, 256
s_cbranch_scc1 L_end
s_setprio 3
v_lshrrev_b32 v2, 6, v0
v_and_b32 v0, 63, v0
v_readfirstlane_b32 s48, v2
s_and_b32 s76, s2, 31
s_lshl_b32 s76, s76, 2
s_lshr_b32 s3, s2, 5
s_and_b32 s72, s3, 3
s_add_u32 s76, s76, s72
s_lshr_b32 s3, s2, 7
s_lshl_b32 s3, s3, 7
s_add_u32 s76, s76, s3
s_lshr_b32 s49, s76, 7
s_lshr_b32 s50, s76, 2
s_and_b32 s50, s50, 31
s_and_b32 s51, s76, 3
s_lshl_b32 s3, s49, 2
s_add_u32 s51, s51, s3
s_mul_i32 s76, s76, 393216
s_mul_i32 s77, s48, 49152
s_add_u32 s76, s76, s77
v_lshrrev_b32 v2, 3, v0
v_and_b32 v3, 7, v0
v_mul_u32_u24 v1, 384, v2
v_lshl_add_u32 v1, v3, 4, v1
v_add_u32 v1, s76, v1
s_min_u32 s77, s2, 239
s_mul_hi_u32 s78, s77, 0x33333334
s_mul_i32 s79, s78, 5
s_sub_u32 s79, s77, s79
s_mul_i32 s3, s48, 1280
v_lshl_add_u32 v44, v0, 2, s3
s_mov_b32 s30, 100663296
s_mov_b32 s31, 0x20000
s_mov_b32 s34, 100663296
s_mov_b32 s35, 0x20000
s_mov_b32 s38, 2498560
s_mov_b32 s39, 0x20000
s_mov_b32 s46, 2560
s_mov_b32 s47, 0x20000
s_mov_b32 s43, 0x20000
s_cmp_ge_u32 s48, 5
s_cbranch_scc1 L_preF
v_add_u32 v45, 0, v0
v_mul_u32_u24 v46, 2731, v45
v_lshrrev_b32 v46, 16, v46
v_mul_u32_u24 v47, 24, v46
v_sub_u32 v45, v45, v47
v_mul_u32_u24 v46, 12288, v46
v_lshl_add_u32 v48, v45, 4, v46
v_add_u32 v45, 64, v0
v_mul_u32_u24 v46, 2731, v45
v_lshrrev_b32 v46, 16, v46
v_mul_u32_u24 v47, 24, v46
v_sub_u32 v45, v45, v47
v_mul_u32_u24 v46, 12288, v46
v_lshl_add_u32 v49, v45, 4, v46
v_add_u32 v45, 128, v0
v_mul_u32_u24 v46, 2731, v45
v_lshrrev_b32 v46, 16, v46
v_mul_u32_u24 v47, 24, v46
v_sub_u32 v45, v45, v47
v_mul_u32_u24 v46, 12288, v46
v_lshl_add_u32 v50, v45, 4, v46
s_mul_i32 s72, s51, 983040
s_mul_i32 s3, s50, 384
s_add_u32 s72, s72, s3
s_mul_i32 s3, s48, 196608
s_add_u32 s72, s72, s3
s_mul_i32 s3, s48, 6144
s_add_u32 s3, s3, 4608
s_mov_b32 m0, s3
s_mov_b32 s42, 7864320
s_branch L_preD
L_preF:
s_cmp_ge_u32 s78, 24
s_cselect_b32 s3, 24, 0
s_sub_u32 s3, s78, s3
s_lshl_b32 s72, s3, 7
s_mul_i32 s3, s79, 393216
s_add_u32 s72, s72, s3
s_sub_u32 s73, s48, 5
s_mul_i32 s3, s73, 147456
s_add_u32 s72, s72, s3
s_mul_i32 s3, s73, 6144
s_add_u32 s3, s3, 35328
s_mov_b32 m0, s3
v_lshrrev_b32 v45, 3, v0
v_mul_u32_u24 v45, 3072, v45
v_and_b32 v46, 7, v0
v_lshl_add_u32 v48, v46, 4, v45
v_mov_b32 v49, v48
v_mov_b32 v50, v48
s_mov_b32 s42, 1966080
L_preD:
s_waitcnt lgkmcnt(0)
s_load_dword s54, s[26:27], 0
s_cmp_ge_u32 s48, 2
s_cbranch_scc1 L_nox
s_mov_b32 s44, s4
s_and_b32 s45, s5, 0xffff
buffer_load_dword v112, v44, s[44:47], 0 offen offset:0
buffer_load_dword v113, v44, s[44:47], 0 offen offset:256
buffer_load_dword v114, v44, s[44:47], 0 offen offset:512
buffer_load_dword v115, v44, s[44:47], 0 offen offset:768
buffer_load_dword v116, v44, s[44:47], 0 offen offset:1024
L_nox:
s_cmp_ge_u32 s48, 5
s_cbranch_scc1 L_dmaF
s_mov_b32 s40, s10
s_and_b32 s41, s11, 0xffff
s_nop 0
buffer_load_dwordx4 v48, s[40:43], s72 offen nt lds
s_add_u32 m0, m0, 1024
s_nop 0
buffer_load_dwordx4 v49, s[40:43], s72 offen nt lds
s_add_u32 m0, m0, 1024
s_nop 0
buffer_load_dwordx4 v50, s[40:43], s72 offen nt lds
s_add_u32 s72, s72, 98304
s_add_u32 m0, m0, 1024
s_nop 0
buffer_load_dwordx4 v48, s[40:43], s72 offen nt lds
s_add_u32 m0, m0, 1024
s_nop 0
buffer_load_dwordx4 v49, s[40:43], s72 offen nt lds
s_add_u32 m0, m0, 1024
s_nop 0
buffer_load_dwordx4 v50, s[40:43], s72 offen nt lds
s_branch L_dmaDone
L_dmaF:
s_cmp_ge_u32 s78, 24
s_cselect_b32 s40, s18, s16
s_cselect_b32 s41, s19, s17
s_and_b32 s41, s41, 0xffff
s_cmp_ge_u32 s2, 240
s_cbranch_scc1 L_dmaDone
s_nop 0
buffer_load_dwordx4 v48, s[40:43], s72 offen nt lds
s_add_u32 m0, m0, 1024
s_add_u32 s72, s72, 24576
s_nop 0
buffer_load_dwordx4 v48, s[40:43], s72 offen nt lds
s_add_u32 m0, m0, 1024
s_add_u32 s72, s72, 24576
s_nop 0
buffer_load_dwordx4 v48, s[40:43], s72 offen nt lds
s_add_u32 m0, m0, 1024
s_add_u32 s72, s72, 24576
s_nop 0
buffer_load_dwordx4 v48, s[40:43], s72 offen nt lds
s_cmp_eq_u32 s48, 7
s_cbranch_scc1 L_dmaDone
s_add_u32 m0, m0, 1024
s_add_u32 s72, s72, 24576
s_nop 0
buffer_load_dwordx4 v48, s[40:43], s72 offen nt lds
s_add_u32 m0, m0, 1024
s_add_u32 s72, s72, 24576
s_nop 0
buffer_load_dwordx4 v48, s[40:43], s72 offen nt lds
L_dmaDone:
s_mov_b32 s28, s6
s_and_b32 s29, s7, 0xffff
s_mov_b32 s32, s8
s_and_b32 s33, s9, 0xffff
s_mov_b32 s36, s26
s_and_b32 s37, s27, 0xffff
s_mov_b32 s44, s4
s_and_b32 s45, s5, 0xffff
s_nop 4
s_lshr_b32 s74, s2, 3
s_lshl_b32 s75, s48, 1
s_add_u32 s74, s74, s75
s_add_u32 s75, s74, 0
s_and_b32 s75, s75, 15
s_mul_i32 s56, s75, 3072
s_add_u32 s75, s74, 1
s_and_b32 s75, s75, 15
s_mul_i32 s57, s75, 3072
s_add_u32 s75, s74, 2
s_and_b32 s75, s75, 15
s_mul_i32 s58, s75, 3072
s_add_u32 s75, s74, 3
s_and_b32 s75, s75, 15
s_mul_i32 s59, s75, 3072
s_add_u32 s75, s74, 4
s_and_b32 s75, s75, 15
s_mul_i32 s60, s75, 3072
s_add_u32 s75, s74, 5
s_and_b32 s75, s75, 15
s_mul_i32 s61, s75, 3072
s_add_u32 s75, s74, 6
s_and_b32 s75, s75, 15
s_mul_i32 s62, s75, 3072
s_add_u32 s75, s74, 7
s_and_b32 s75, s75, 15
s_mul_i32 s63, s75, 3072
s_add_u32 s75, s74, 8
s_and_b32 s75, s75, 15
s_mul_i32 s64, s75, 3072
s_add_u32 s75, s74, 9
s_and_b32 s75, s75, 15
s_mul_i32 s65, s75, 3072
s_add_u32 s75, s74, 10
s_and_b32 s75, s75, 15
s_mul_i32 s66, s75, 3072
s_add_u32 s75, s74, 11
s_and_b32 s75, s75, 15
s_mul_i32 s67, s75, 3072
s_add_u32 s75, s74, 12
s_and_b32 s75, s75, 15
s_mul_i32 s68, s75, 3072
s_add_u32 s75, s74, 13
s_and_b32 s75, s75, 15
s_mul_i32 s69, s75, 3072
s_add_u32 s75, s74, 14
s_and_b32 s75, s75, 15
s_mul_i32 s70, s75, 3072
s_add_u32 s75, s74, 15
s_and_b32 s75, s75, 15
s_mul_i32 s71, s75, 3072
s_cmp_eq_u32 s48, 2
s_cbranch_scc0 L_noinit
v_mov_b32 v46, 0xff800000
v_cmp_eq_u32 vcc, 18, v0
v_lshlrev_b32 v45, 2, v0
s_nop 1
v_cndmask_b32 v46, 0, v46, vcc
ds_write_b32 v45, v46 offset:1664
L_noinit:
s_cmp_ge_u32 s48, 2
s_cbranch_scc1 L_noln
s_waitcnt vmcnt(6)
v_lshlrev_b32 v120, 16, v112
v_and_b32 v121, 0xffff0000, v112
v_lshlrev_b32 v122, 16, v113
v_and_b32 v123, 0xffff0000, v113
v_lshlrev_b32 v124, 16, v114
v_and_b32 v125, 0xffff0000, v114
v_lshlrev_b32 v126, 16, v115
v_and_b32 v127, 0xffff0000, v115
v_lshlrev_b32 v128, 16, v116
v_and_b32 v129, 0xffff0000, v116
v_add_f32 v130, v120, v121
v_add_f32 v130, v130, v122
v_add_f32 v130, v130, v123
v_add_f32 v130, v130, v124
v_add_f32 v130, v130, v125
v_add_f32 v130, v130, v126
v_add_f32 v130, v130, v127
v_add_f32 v130, v130, v128
v_add_f32 v130, v130, v129
s_nop 1
v_add_f32_dpp v130, v130, v130 quad_perm:[1,0,3,2] row_mask:0xf bank_mask:0xf
s_nop 1
v_add_f32_dpp v130, v130, v130 quad_perm:[2,3,0,1] row_mask:0xf bank_mask:0xf
s_nop 1
v_add_f32_dpp v130, v130, v130 row_half_mirror row_mask:0xf bank_mask:0xf
s_nop 1
v_add_f32_dpp v130, v130, v130 row_mirror row_mask:0xf bank_mask:0xf
v_mov_b32 v131, v130
s_nop 1
v_permlane16_swap_b32 v130, v131
s_nop 0
v_add_f32 v130, v130, v131
v_mov_b32 v131, v130
s_nop 1
v_permlane32_swap_b32 v130, v131
s_nop 0
v_add_f32 v130, v130, v131
v_mul_f32 v130, 0x3acccccd, v130
v_sub_f32 v132, v120, v130
v_sub_f32 v133, v121, v130
v_sub_f32 v134, v122, v130
v_sub_f32 v135, v123, v130
v_sub_f32 v136, v124, v130
v_sub_f32 v137, v125, v130
v_sub_f32 v138, v126, v130
v_sub_f32 v139, v127, v130
v_sub_f32 v140, v128, v130
v_sub_f32 v141, v129, v130
v_mul_f32 v142, v132, v132
v_fmac_f32 v142, v133, v133
v_fmac_f32 v142, v134, v134
v_fmac_f32 v142, v135, v135
v_fmac_f32 v142, v136, v136
v_fmac_f32 v142, v137, v137
v_fmac_f32 v142, v138, v138
v_fmac_f32 v142, v139, v139
v_fmac_f32 v142, v140, v140
v_fmac_f32 v142, v141, v141
s_nop 1
v_add_f32_dpp v142, v142, v142 quad_perm:[1,0,3,2] row_mask:0xf bank_mask:0xf
s_nop 1
v_add_f32_dpp v142, v142, v142 quad_perm:[2,3,0,1] row_mask:0xf bank_mask:0xf
s_nop 1
v_add_f32_dpp v142, v142, v142 row_half_mirror row_mask:0xf bank_mask:0xf
s_nop 1
v_add_f32_dpp v142, v142, v142 row_mirror row_mask:0xf bank_mask:0xf
v_mov_b32 v131, v142
s_nop 1
v_permlane16_swap_b32 v142, v131
s_nop 0
v_add_f32 v142, v142, v131
v_mov_b32 v131, v142
s_nop 1
v_permlane32_swap_b32 v142, v131
s_nop 0
v_add_f32 v142, v142, v131
v_mul_f32 v142, 0x3acccccd, v142
v_cvt_pk_bf16_f32 v143, v130, v142
v_lshlrev_b32 v130, 16, v143
v_and_b32 v142, 0xffff0000, v143
v_add_f32 v142, 0x3727c5ac, v142
v_cvt_pk_bf16_f32 v142, v142, v142
v_lshlrev_b32 v142, 16, v142
v_sqrt_f32 v142, v142
s_nop 0
v_cvt_pk_bf16_f32 v142, v142, v142
v_lshlrev_b32 v142, 16, v142
v_rcp_f32 v143, v142
v_sub_f32 v132, v120, v130
v_sub_f32 v133, v121, v130
v_cvt_pk_bf16_f32 v112, v132, v133
v_sub_f32 v134, v122, v130
v_sub_f32 v135, v123, v130
v_cvt_pk_bf16_f32 v113, v134, v135
v_sub_f32 v136, v124, v130
v_sub_f32 v137, v125, v130
v_cvt_pk_bf16_f32 v114, v136, v137
v_sub_f32 v138, v126, v130
v_sub_f32 v139, v127, v130
v_cvt_pk_bf16_f32 v115, v138, v139
v_sub_f32 v140, v128, v130
v_sub_f32 v141, v129, v130
v_cvt_pk_bf16_f32 v116, v140, v141
v_lshlrev_b32 v132, 16, v112
v_and_b32 v133, 0xffff0000, v112
v_lshlrev_b32 v134, 16, v113
v_and_b32 v135, 0xffff0000, v113
v_lshlrev_b32 v136, 16, v114
v_and_b32 v137, 0xffff0000, v114
v_lshlrev_b32 v138, 16, v115
v_and_b32 v139, 0xffff0000, v115
v_lshlrev_b32 v140, 16, v116
v_and_b32 v141, 0xffff0000, v116
v_mul_f32 v120, v132, v143
v_mul_f32 v121, v133, v143
v_mul_f32 v122, v134, v143
v_mul_f32 v123, v135, v143
v_mul_f32 v124, v136, v143
v_mul_f32 v125, v137, v143
v_mul_f32 v126, v138, v143
v_mul_f32 v127, v139, v143
v_mul_f32 v128, v140, v143
v_mul_f32 v129, v141, v143
v_fma_f32 v132, -v120, v142, v132
v_fma_f32 v133, -v121, v142, v133
v_fma_f32 v134, -v122, v142, v134
v_fma_f32 v135, -v123, v142, v135
v_fma_f32 v136, -v124, v142, v136
v_fma_f32 v137, -v125, v142, v137
v_fma_f32 v138, -v126, v142, v138
v_fma_f32 v139, -v127, v142, v139
v_fma_f32 v140, -v128, v142, v140
v_fma_f32 v141, -v129, v142, v141
v_fmac_f32 v120, v132, v143
v_fmac_f32 v121, v133, v143
v_fmac_f32 v122, v134, v143
v_fmac_f32 v123, v135, v143
v_fmac_f32 v124, v136, v143
v_fmac_f32 v125, v137, v143
v_fmac_f32 v126, v138, v143
v_fmac_f32 v127, v139, v143
v_fmac_f32 v128, v140, v143
v_fmac_f32 v129, v141, v143
s_mul_i32 s3, s48, 1280
v_lshl_add_u32 v44, v0, 2, s3
v_cvt_pk_bf16_f32 v112, v120, v121
v_cvt_pk_bf16_f32 v113, v122, v123
v_cvt_pk_bf16_f32 v114, v124, v125
v_cvt_pk_bf16_f32 v115, v126, v127
v_cvt_pk_bf16_f32 v116, v128, v129
ds_write_b32 v44, v112 offset:2048
ds_write_b32 v44, v113 offset:2304
ds_write_b32 v44, v114 offset:2560
ds_write_b32 v44, v115 offset:2816
ds_write_b32 v44, v116 offset:3072
L_noln:
s_waitcnt vmcnt(5)
buffer_load_dwordx4 v[64:67], v1, s[28:31], s56 offen offset:0 nt
s_waitcnt vmcnt(5)
buffer_load_dwordx4 v[68:71], v1, s[28:31], s56 offen offset:128 nt
s_waitcnt vmcnt(5)
buffer_load_dwordx4 v[72:75], v1, s[28:31], s56 offen offset:256 nt
s_waitcnt vmcnt(5)
buffer_load_dwordx4 v[76:79], v1, s[28:31], s57 offen offset:0 nt
s_waitcnt vmcnt(5)
buffer_load_dwordx4 v[80:83], v1, s[28:31], s57 offen offset:128 nt
s_waitcnt vmcnt(5)
buffer_load_dwordx4 v[84:87], v1, s[28:31], s57 offen offset:256 nt
s_waitcnt vmcnt(5)
buffer_load_dwordx4 v[88:91], v1, s[28:31], s58 offen offset:0 nt
s_waitcnt vmcnt(5)
buffer_load_dwordx4 v[92:95], v1, s[28:31], s58 offen offset:128 nt
s_waitcnt vmcnt(5)
buffer_load_dwordx4 v[96:99], v1, s[28:31], s58 offen offset:256 nt
s_waitcnt vmcnt(5)
buffer_load_dwordx4 v[100:103], v1, s[28:31], s59 offen offset:0 nt
s_waitcnt vmcnt(5)
buffer_load_dwordx4 v[104:107], v1, s[28:31], s59 offen offset:128 nt
s_waitcnt vmcnt(5)
buffer_load_dwordx4 v[108:111], v1, s[28:31], s59 offen offset:256 nt
v_mov_b32 v44, 0
s_cmp_eq_u32 s48, 2
s_cbranch_scc0 L_wm3
global_load_dword v240, v44, s[22:23]
s_mul_i32 s3, s50, 245760
s_mul_i32 s72, s51, 30720
s_add_u32 s3, s3, s72
v_mov_b32 v45, s3
global_load_dword v241, v45, s[12:13]
s_branch L_wmd
L_wm3:
s_cmp_eq_u32 s48, 3
s_cbranch_scc0 L_wm4
s_min_u32 s3, s2, 191
s_mul_i32 s3, s3, 10240
v_mov_b32 v46, s3
global_load_dword v240, v46, s[20:21]
buffer_load_dword v241, v1, s[32:35], 0 offen
s_branch L_wmd
L_wm4:
s_cmp_eq_u32 s48, 4
s_cbranch_scc0 L_wm5
s_lshl_b32 s3, s50, 13
s_lshl_b32 s72, s51, 10
s_add_u32 s3, s3, s72
s_add_u32 s3, s3, 917504
v_lshl_add_u32 v47, v0, 4, s3
buffer_load_dword v240, v47, s[36:39], 0 offen sc1
v_lshlrev_b32 v47, 15, v0
v_min_u32 v47, 1277952, v47
s_lshl_b32 s3, s2, 7
s_add_u32 s3, s3, 1179648
v_add_u32 v47, s3, v47
buffer_load_dword v241, v47, s[36:39], 0 offen sc1
s_branch L_wmd
L_wm5:
s_getpc_b64 s[72:73]
L_pc0:
s_add_u32 s72, s72, L_codewarm_from-L_pc0
s_addc_u32 s73, s73, 0
v_lshlrev_b32 v44, 7, v0
v_min_u32 v44, L_end-L_codewarm_from, v44
global_load_dword v240, v44, s[72:73]
v_add_u32 v44, 64, v44
v_min_u32 v44, L_end-L_codewarm_from, v44
global_load_dword v241, v44, s[72:73]
L_wmd:
s_waitcnt vmcnt(14) lgkmcnt(0)
s_add_u32 s3, s54, 1
s_mul_i32 s53, s3, 0x9E3779B1
s_bfe_u32 s3, s53, 0x90010
s_add_u32 s3, s3, 16
s_add_u32 s3, s3, s54
s_and_b32 s52, s3, 0x3ff
s_lshr_b32 s54, s54, 10
s_add_u32 s54, s54, 1
s_lshl_b32 s54, s54, 10
s_or_b32 s54, s54, s52
s_mov_b32 s55, 0xfffffc00
v_mov_b32 v63, s52
v_mov_b32 v62, s53
s_barrier
s_cmp_eq_u32 s48, 0
s_cbranch_scc1 L_p0done
s_cmp_eq_u32 s48, 7
s_cbranch_scc1 L_p0x
v_lshrrev_b32 v45, 4, v0
v_bfe_u32 v46, v0, 2, 2
v_and_b32 v47, 3, v0
v_and_b32 v48, 1, v0
v_lshl_add_u32 v49, v45, 3, v46
v_mul_u32_u24 v52, 1280, v48
s_cmp_ge_u32 s48, 5
s_cbranch_scc1 L_ffn0c
v_mul_u32_u24 v50, 384, v49
v_lshl_add_u32 v50, v47, 3, v50
v_lshl_add_u32 v51, v45, 2, v46
v_mul_u32_u24 v51, 384, v51
v_lshl_add_u32 v51, v47, 3, v51
s_sub_u32 s73, s48, 1
s_mul_i32 s3, s73, 96
v_add_u32 v50, s3, v50
v_add_u32 v51, s3, v51
s_mul_i32 s3, s51, 160
v_add_u32 v53, s3, v52
v_lshl_add_u32 v54, v45, 3, v53
v_lshl_add_u32 v53, v45, 4, v53
ds_read_b128 v[112:115], v53 offset:2048
ds_read_b128 v[116:119], v53 offset:2112
ds_read_b64 v[120:121], v54 offset:2176
s_lshl_b32 s3, s50, 3
s_add_u32 s3, s3, s51
s_mul_i32 s3, s3, 3072
s_mul_i32 s72, s73, 384
s_add_u32 s3, s3, s72
s_add_u32 s3, s3, 4096
v_mul_u32_u24 v55, 1536, v48
v_lshl_add_u32 v55, v45, 5, v55
v_add_u32 v55, s3, v55
v_bfe_u32 v56, v0, 1, 1
v_lshl_add_u32 v55, v56, 4, v55
v_cmp_eq_u32 s[74:75], 1, v56
ds_read_b64_tr_b16 v[124:125], v50 offset:4608
ds_read_b64_tr_b16 v[126:127], v50 offset:6144
ds_read_b64_tr_b16 v[128:129], v50 offset:16896
ds_read_b64_tr_b16 v[130:131], v50 offset:18432
ds_read_b64_tr_b16 v[132:133], v51 offset:29184
ds_read_b64_tr_b16 v[134:135], v50 offset:4640
ds_read_b64_tr_b16 v[136:137], v50 offset:6176
ds_read_b64_tr_b16 v[138:139], v50 offset:16928
ds_read_b64_tr_b16 v[140:141], v50 offset:18464
ds_read_b64_tr_b16 v[142:143], v51 offset:29216
s_waitcnt lgkmcnt(5)
v_mfma_f32_16x16x32_bf16 v[160:163], v[124:127], v[112:115], 0
v_mfma_f32_16x16x32_bf16 v[160:163], v[128:131], v[116:119], v[160:163]
s_nop 5
v_mfma_f32_16x16x16_bf16 v[160:163], v[132:133], v[120:121], v[160:163]
ds_read_b64_tr_b16 v[144:145], v50 offset:4672
ds_read_b64_tr_b16 v[146:147], v50 offset:6208
ds_read_b64_tr_b16 v[148:149], v50 offset:16960
ds_read_b64_tr_b16 v[150:151], v50 offset:18496
ds_read_b64_tr_b16 v[152:153], v51 offset:29248
s_waitcnt lgkmcnt(5)
v_mfma_f32_16x16x32_bf16 v[164:167], v[134:137], v[112:115], 0
v_mfma_f32_16x16x32_bf16 v[164:167], v[138:141], v[116:119], v[164:167]
s_nop 5
v_mfma_f32_16x16x16_bf16 v[164:167], v[142:143], v[120:121], v[164:167]
s_waitcnt lgkmcnt(0)
v_mfma_f32_16x16x32_bf16 v[168:171], v[144:147], v[112:115], 0
v_mfma_f32_16x16x32_bf16 v[168:171], v[148:151], v[116:119], v[168:171]
s_nop 5
v_mfma_f32_16x16x16_bf16 v[168:171], v[152:153], v[120:121], v[168:171]
s_mov_b32 exec_lo, 0x000f000f
s_mov_b32 exec_hi, 0x000f000f
s_nop 1
v_cndmask_b32 v56, v160, v162, s[74:75]
v_mov_b32 v57, v62
v_cndmask_b32 v58, v161, v163, s[74:75]
v_mov_b32 v59, v62
buffer_store_dwordx4 v[56:59], v55, s[36:39], 0 offen offset:0 sc1
s_nop 1
v_cndmask_b32 v32, v164, v166, s[74:75]
v_mov_b32 v33, v62
v_cndmask_b32 v34, v165, v167, s[74:75]
v_mov_b32 v35, v62
buffer_store_dwordx4 v[32:35], v55, s[36:39], 0 offen offset:128 sc1
s_nop 1
v_cndmask_b32 v56, v168, v170, s[74:75]
v_mov_b32 v57, v62
v_cndmask_b32 v58, v169, v171, s[74:75]
v_mov_b32 v59, v62
buffer_store_dwordx4 v[56:59], v55, s[36:39], 0 offen offset:256 sc1
s_mov_b64 exec, -1
s_branch L_p0done
L_ffn0c:
s_cmp_ge_u32 s2, 240
s_cbranch_scc1 L_p0done
L_ffn0:
v_lshlrev_b32 v50, 7, v49
v_lshl_add_u32 v50, v47, 3, v50
s_sub_u32 s73, s48, 5
s_lshl_b32 s3, s73, 6
v_add_u32 v50, s3, v50
s_lshl_b32 s3, s79, 8
v_add_u32 v53, s3, v52
v_lshl_add_u32 v53, v45, 4, v53
ds_read_b128 v[112:115], v53 offset:2048
ds_read_b128 v[116:119], v53 offset:2112
ds_read_b128 v[120:123], v53 offset:2176
ds_read_b128 v[124:127], v53 offset:2240
ds_read_b64_tr_b16 v[128:129], v50 offset:35328
ds_read_b64_tr_b16 v[130:131], v50 offset:35840
ds_read_b64_tr_b16 v[132:133], v50 offset:39424
ds_read_b64_tr_b16 v[134:135], v50 offset:39936
ds_read_b64_tr_b16 v[136:137], v50 offset:43520
ds_read_b64_tr_b16 v[138:139], v50 offset:44032
ds_read_b64_tr_b16 v[140:141], v50 offset:47616
ds_read_b64_tr_b16 v[142:143], v50 offset:48128
s_mul_i32 s3, s78, 5
s_add_u32 s3, s3, s79
s_lshl_b32 s3, s3, 9
s_lshl_b32 s72, s73, 7
s_add_u32 s3, s3, s72
s_add_u32 s3, s3, 794624
v_lshlrev_b32 v60, 8, v48
v_lshl_add_u32 v60, v45, 4, v60
v_add_u32 v60, s3, v60
s_waitcnt lgkmcnt(0)
ds_read_b64_tr_b16 v[144:145], v50 offset:35360
ds_read_b64_tr_b16 v[146:147], v50 offset:35872
ds_read_b64_tr_b16 v[148:149], v50 offset:39456
ds_read_b64_tr_b16 v[150:151], v50 offset:39968
ds_read_b64_tr_b16 v[152:153], v50 offset:43552
ds_read_b64_tr_b16 v[154:155], v50 offset:44064
ds_read_b64_tr_b16 v[156:157], v50 offset:47648
ds_read_b64_tr_b16 v[158:159], v50 offset:48160
v_mfma_f32_16x16x32_bf16 v[160:163], v[128:131], v[112:115], 0
v_mfma_f32_16x16x32_bf16 v[160:163], v[132:135], v[116:119], v[160:163]
v_mfma_f32_16x16x32_bf16 v[160:163], v[136:139], v[120:123], v[160:163]
v_mfma_f32_16x16x32_bf16 v[160:163], v[140:143], v[124:127], v[160:163]
s_waitcnt lgkmcnt(0)
v_mfma_f32_16x16x32_bf16 v[164:167], v[144:147], v[112:115], 0
v_mfma_f32_16x16x32_bf16 v[164:167], v[148:151], v[116:119], v[164:167]
v_mfma_f32_16x16x32_bf16 v[164:167], v[152:155], v[120:123], v[164:167]
v_mfma_f32_16x16x32_bf16 v[164:167], v[156:159], v[124:127], v[164:167]
s_mov_b32 exec_lo, 0x00030003
s_mov_b32 exec_hi, 0x00030003
s_nop 3
v_bfi_b32 v160, s55, v160, v63
v_bfi_b32 v161, s55, v161, v63
v_bfi_b32 v162, s55, v162, v63
v_bfi_b32 v163, s55, v163, v63
buffer_store_dwordx4 v[160:163], v60, s[36:39], 0 offen sc1
s_nop 1
v_bfi_b32 v164, s55, v164, v63
v_bfi_b32 v165, s55, v165, v63
v_bfi_b32 v166, s55, v166, v63
v_bfi_b32 v167, s55, v167, v63
buffer_store_dwordx4 v[164:167], v60, s[36:39], 0 offen offset:64 sc1
s_mov_b64 exec, -1
s_branch L_p0done
L_p0x:
s_getreg_b32 s3, hwreg(HW_REG_XCC_ID)
s_and_b32 s3, s3, 15
v_mov_b32 v56, s3
v_mov_b32 v57, v62
v_mov_b32 v58, s3
v_mov_b32 v59, v62
s_lshl_b32 s3, s50, 3
s_add_u32 s3, s3, s51
s_lshl_b32 s3, s3, 4
s_add_u32 s3, s3, 2494464
v_mov_b32 v55, s3
s_mov_b64 exec, 1
buffer_store_dwordx4 v[56:59], v55, s[36:39], 0 offen sc1
s_mov_b64 exec, -1
L_p0done:
s_barrier
s_setprio 0
s_waitcnt vmcnt(2)
buffer_load_dwordx4 v[112:115], v1, s[28:31], s60 offen offset:0 nt
s_mul_i32 s3, s50, 24576
s_mul_i32 s72, s49, 1536
s_add_u32 s3, s3, s72
s_add_u32 s3, s3, 4096
v_lshl_add_u32 v44, v0, 4, s3
v_and_b32 v45, 31, v0
v_lshlrev_b32 v45, 4, v45
v_add_u32 v45, s3, v45
v_add_u32 v45, 1024, v45
v_add_u32 v224, 0, v44
v_add_u32 v232, 0, v45
v_add_u32 v225, 3072, v44
v_add_u32 v233, 3072, v45
v_add_u32 v226, 6144, v44
v_add_u32 v234, 6144, v45
v_add_u32 v227, 9216, v44
v_add_u32 v235, 9216, v45
v_add_u32 v228, 12288, v44
v_add_u32 v236, 12288, v45
v_add_u32 v229, 15360, v44
v_add_u32 v237, 15360, v45
v_add_u32 v230, 18432, v44
v_add_u32 v238, 18432, v45
v_add_u32 v231, 21504, v44
v_add_u32 v239, 21504, v45
s_lshl_b32 s3, s50, 7
s_add_u32 s3, s3, 2494464
v_and_b32 v44, 7, v0
v_lshl_add_u32 v244, v44, 4, s3
s_waitcnt vmcnt(2)
buffer_load_dwordx4 v[116:119], v1, s[28:31], s60 offen offset:128 nt
s_waitcnt vmcnt(2)
buffer_load_dwordx4 v[120:123], v1, s[28:31], s60 offen offset:256 nt
s_waitcnt vmcnt(2)
buffer_load_dwordx4 v[124:127], v1, s[28:31], s61 offen offset:0 nt
v_and_b32 v44, 7, v0
v_cmp_eq_u32 vcc, 0, v44
v_mov_b32 v45, 0xffff
v_cmp_eq_u32 s[72:73], 1, v44
v_mov_b32 v46, 0xffff0000
v_cndmask_b32 v40, 0, v45, vcc
s_nop 0
v_cndmask_b32 v40, v40, v46, s[72:73]
v_cmp_eq_u32 vcc, 2, v44
v_mov_b32 v45, 0xffff
v_cmp_eq_u32 s[72:73], 3, v44
v_mov_b32 v46, 0xffff0000
v_cndmask_b32 v41, 0, v45, vcc
s_nop 0
v_cndmask_b32 v41, v41, v46, s[72:73]
v_cmp_eq_u32 vcc, 4, v44
v_mov_b32 v45, 0xffff
v_cmp_eq_u32 s[72:73], 5, v44
v_mov_b32 v46, 0xffff0000
v_cndmask_b32 v42, 0, v45, vcc
s_nop 0
v_cndmask_b32 v42, v42, v46, s[72:73]
v_cmp_eq_u32 vcc, 6, v44
v_mov_b32 v45, 0xffff
v_cmp_eq_u32 s[72:73], 7, v44
v_mov_b32 v46, 0xffff0000
v_cndmask_b32 v43, 0, v45, vcc
s_nop 0
v_cndmask_b32 v43, v43, v46, s[72:73]
s_waitcnt vmcnt(2)
buffer_load_dwordx4 v[128:131], v1, s[28:31], s61 offen offset:128 nt
s_waitcnt vmcnt(2)
buffer_load_dwordx4 v[132:135], v1, s[28:31], s61 offen offset:256 nt
s_waitcnt vmcnt(2)
buffer_load_dwordx4 v[136:139], v1, s[28:31], s62 offen offset:0 nt
s_waitcnt vmcnt(2)
buffer_load_dwordx4 v[140:143], v1, s[28:31], s62 offen offset:128 nt
s_waitcnt vmcnt(2)
buffer_load_dwordx4 v[144:147], v1, s[28:31], s62 offen offset:256 nt
s_cmp_eq_u32 s48, 0
s_cbranch_scc0 L_t_norm
buffer_load_dwordx4 v[240:243], v244, s[36:39], 0 offen sc1
buffer_load_dwordx4 v[160:163], v224, s[36:39], 0 offen sc1
buffer_load_dwordx4 v[164:167], v232, s[36:39], 0 offen sc1
buffer_load_dwordx4 v[168:171], v225, s[36:39], 0 offen sc1
buffer_load_dwordx4 v[172:175], v233, s[36:39], 0 offen sc1
buffer_load_dwordx4 v[176:179], v226, s[36:39], 0 offen sc1
buffer_load_dwordx4 v[180:183], v234, s[36:39], 0 offen sc1
buffer_load_dwordx4 v[184:187], v227, s[36:39], 0 offen sc1
buffer_load_dwordx4 v[188:191], v235, s[36:39], 0 offen sc1
buffer_load_dwordx4 v[192:195], v228, s[36:39], 0 offen sc1
buffer_load_dwordx4 v[196:199], v236, s[36:39], 0 offen sc1
buffer_load_dwordx4 v[200:203], v229, s[36:39], 0 offen sc1
buffer_load_dwordx4 v[204:207], v237, s[36:39], 0 offen sc1
buffer_load_dwordx4 v[208:211], v230, s[36:39], 0 offen sc1
buffer_load_dwordx4 v[212:215], v238, s[36:39], 0 offen sc1
buffer_load_dwordx4 v[216:219], v231, s[36:39], 0 offen sc1
buffer_load_dwordx4 v[220:223], v239, s[36:39], 0 offen sc1
s_waitcnt vmcnt(19)
buffer_load_dwordx4 v[148:151], v1, s[28:31], s63 offen offset:0 nt
s_waitcnt vmcnt(19)
buffer_load_dwordx4 v[152:155], v1, s[28:31], s63 offen offset:128 nt
s_waitcnt vmcnt(19)
buffer_load_dwordx4 v[156:159], v1, s[28:31], s63 offen offset:256 nt
s_waitcnt vmcnt(3)
s_mov_b32 s74, 0
v_xor_b32 v46, v161, v62
v_bitop3_b32 v46, v46, v241, v62 bitop3:0xf6
v_bitop3_b32 v46, v46, v243, v62 bitop3:0xf6
v_bitop3_b32 v46, v46, v163, v62 bitop3:0xf6
v_bitop3_b32 v46, v46, v165, v62 bitop3:0xf6
v_bitop3_b32 v46, v46, v167, v62 bitop3:0xf6
v_bitop3_b32 v46, v46, v169, v62 bitop3:0xf6
v_bitop3_b32 v46, v46, v171, v62 bitop3:0xf6
v_bitop3_b32 v46, v46, v173, v62 bitop3:0xf6
v_bitop3_b32 v46, v46, v175, v62 bitop3:0xf6
v_bitop3_b32 v46, v46, v177, v62 bitop3:0xf6
v_bitop3_b32 v46, v46, v179, v62 bitop3:0xf6
v_bitop3_b32 v46, v46, v181, v62 bitop3:0xf6
v_bitop3_b32 v46, v46, v183, v62 bitop3:0xf6
v_bitop3_b32 v46, v46, v185, v62 bitop3:0xf6
v_bitop3_b32 v46, v46, v187, v62 bitop3:0xf6
v_bitop3_b32 v46, v46, v189, v62 bitop3:0xf6
v_bitop3_b32 v46, v46, v191, v62 bitop3:0xf6
v_bitop3_b32 v46, v46, v193, v62 bitop3:0xf6
v_bitop3_b32 v46, v46, v195, v62 bitop3:0xf6
v_bitop3_b32 v46, v46, v197, v62 bitop3:0xf6
v_bitop3_b32 v46, v46, v199, v62 bitop3:0xf6
v_bitop3_b32 v46, v46, v201, v62 bitop3:0xf6
v_bitop3_b32 v46, v46, v203, v62 bitop3:0xf6
v_bitop3_b32 v46, v46, v205, v62 bitop3:0xf6
v_bitop3_b32 v46, v46, v207, v62 bitop3:0xf6
v_bitop3_b32 v46, v46, v209, v62 bitop3:0xf6
v_bitop3_b32 v46, v46, v211, v62 bitop3:0xf6
v_bitop3_b32 v46, v46, v213, v62 bitop3:0xf6
v_bitop3_b32 v46, v46, v215, v62 bitop3:0xf6
v_bitop3_b32 v46, v46, v217, v62 bitop3:0xf6
v_bitop3_b32 v46, v46, v219, v62 bitop3:0xf6
v_bitop3_b32 v46, v46, v221, v62 bitop3:0xf6
v_bitop3_b32 v46, v46, v223, v62 bitop3:0xf6
v_cmp_ne_u32 vcc, 0, v46
s_add_u32 s74, s74, 1
s_nop 3
s_cmp_eq_u64 vcc, 0
s_cbranch_scc1 L_qok
L_qpoll:
s_sleep 2
buffer_load_dwordx4 v[240:243], v244, s[36:39], 0 offen sc1
buffer_load_dwordx4 v[160:163], v224, s[36:39], 0 offen sc1
buffer_load_dwordx4 v[164:167], v232, s[36:39], 0 offen sc1
buffer_load_dwordx4 v[168:171], v225, s[36:39], 0 offen sc1
buffer_load_dwordx4 v[172:175], v233, s[36:39], 0 offen sc1
buffer_load_dwordx4 v[176:179], v226, s[36:39], 0 offen sc1
buffer_load_dwordx4 v[180:183], v234, s[36:39], 0 offen sc1
buffer_load_dwordx4 v[184:187], v227, s[36:39], 0 offen sc1
buffer_load_dwordx4 v[188:191], v235, s[36:39], 0 offen sc1
buffer_load_dwordx4 v[192:195], v228, s[36:39], 0 offen sc1
buffer_load_dwordx4 v[196:199], v236, s[36:39], 0 offen sc1
buffer_load_dwordx4 v[200:203], v229, s[36:39], 0 offen sc1
buffer_load_dwordx4 v[204:207], v237, s[36:39], 0 offen sc1
buffer_load_dwordx4 v[208:211], v230, s[36:39], 0 offen sc1
buffer_load_dwordx4 v[212:215], v238, s[36:39], 0 offen sc1
buffer_load_dwordx4 v[216:219], v231, s[36:39], 0 offen sc1
buffer_load_dwordx4 v[220:223], v239, s[36:39], 0 offen sc1
s_waitcnt vmcnt(0)
v_xor_b32 v46, v161, v62
v_bitop3_b32 v46, v46, v241, v62 bitop3:0xf6
v_bitop3_b32 v46, v46, v243, v62 bitop3:0xf6
v_bitop3_b32 v46, v46, v163, v62 bitop3:0xf6
v_bitop3_b32 v46, v46, v165, v62 bitop3:0xf6
v_bitop3_b32 v46, v46, v167, v62 bitop3:0xf6
v_bitop3_b32 v46, v46, v169, v62 bitop3:0xf6
v_bitop3_b32 v46, v46, v171, v62 bitop3:0xf6
v_bitop3_b32 v46, v46, v173, v62 bitop3:0xf6
v_bitop3_b32 v46, v46, v175, v62 bitop3:0xf6
v_bitop3_b32 v46, v46, v177, v62 bitop3:0xf6
v_bitop3_b32 v46, v46, v179, v62 bitop3:0xf6
v_bitop3_b32 v46, v46, v181, v62 bitop3:0xf6
v_bitop3_b32 v46, v46, v183, v62 bitop3:0xf6
v_bitop3_b32 v46, v46, v185, v62 bitop3:0xf6
v_bitop3_b32 v46, v46, v187, v62 bitop3:0xf6
v_bitop3_b32 v46, v46, v189, v62 bitop3:0xf6
v_bitop3_b32 v46, v46, v191, v62 bitop3:0xf6
v_bitop3_b32 v46, v46, v193, v62 bitop3:0xf6
v_bitop3_b32 v46, v46, v195, v62 bitop3:0xf6
v_bitop3_b32 v46, v46, v197, v62 bitop3:0xf6
v_bitop3_b32 v46, v46, v199, v62 bitop3:0xf6
v_bitop3_b32 v46, v46, v201, v62 bitop3:0xf6
v_bitop3_b32 v46, v46, v203, v62 bitop3:0xf6
v_bitop3_b32 v46, v46, v205, v62 bitop3:0xf6
v_bitop3_b32 v46, v46, v207, v62 bitop3:0xf6
v_bitop3_b32 v46, v46, v209, v62 bitop3:0xf6
v_bitop3_b32 v46, v46, v211, v62 bitop3:0xf6
v_bitop3_b32 v46, v46, v213, v62 bitop3:0xf6
v_bitop3_b32 v46, v46, v215, v62 bitop3:0xf6
v_bitop3_b32 v46, v46, v217, v62 bitop3:0xf6
v_bitop3_b32 v46, v46, v219, v62 bitop3:0xf6
v_bitop3_b32 v46, v46, v221, v62 bitop3:0xf6
v_bitop3_b32 v46, v46, v223, v62 bitop3:0xf6
v_cmp_ne_u32 vcc, 0, v46
s_add_u32 s74, s74, 1
s_nop 3
s_cmp_eq_u64 vcc, 0
s_cbranch_scc1 L_qok
s_cmp_lt_u32 s74, 200000
s_cbranch_scc1 L_qpoll
v_mov_b32 v46, 257
v_mov_b32 v47, 0
global_store_dword v47, v46, s[24:25]
L_qok:
v_add_f32 v160, v160, v168
v_add_f32 v160, v160, v176
v_add_f32 v160, v160, v184
v_add_f32 v160, v160, v192
v_add_f32 v160, v160, v200
v_add_f32 v160, v160, v208
v_add_f32 v160, v160, v216
v_add_f32 v164, v164, v172
v_add_f32 v164, v164, v180
v_add_f32 v164, v164, v188
v_add_f32 v164, v164, v196
v_add_f32 v164, v164, v204
v_add_f32 v164, v164, v212
v_add_f32 v164, v164, v220
v_add_f32 v162, v162, v170
v_add_f32 v162, v162, v178
v_add_f32 v162, v162, v186
v_add_f32 v162, v162, v194
v_add_f32 v162, v162, v202
v_add_f32 v162, v162, v210
v_add_f32 v162, v162, v218
v_add_f32 v166, v166, v174
v_add_f32 v166, v166, v182
v_add_f32 v166, v166, v190
v_add_f32 v166, v166, v198
v_add_f32 v166, v166, v206
v_add_f32 v166, v166, v214
v_add_f32 v166, v166, v222
v_cvt_pk_bf16_f32 v46, v160, v162
v_cvt_pk_bf16_f32 v47, v164, v166
v_lshlrev_b32 v50, 2, v0
v_and_b32 v51, 31, v0
v_lshlrev_b32 v51, 2, v51
ds_write_b32 v50, v46 offset:0
ds_write_b32 v51, v47 offset:256
s_getreg_b32 s3, hwreg(HW_REG_XCC_ID)
s_and_b32 s3, s3, 15
v_cmp_ne_u32 vcc, s3, v240
v_mov_b32 v47, 0
s_nop 3
s_cmp_eq_u64 vcc, 0
s_cselect_b32 s3, 1, 0
v_mov_b32 v46, s3
ds_write_b32 v47, v46 offset:1744
v_mov_b32 v46, 1
v_mov_b32 v47, 0
ds_write_b32 v47, v46 offset:1728
s_branch L_t_join
L_t_norm:
s_waitcnt vmcnt(2)
buffer_load_dwordx4 v[148:151], v1, s[28:31], s63 offen offset:0 nt
s_waitcnt vmcnt(2)
buffer_load_dwordx4 v[152:155], v1, s[28:31], s63 offen offset:128 nt
s_waitcnt vmcnt(2)
buffer_load_dwordx4 v[156:159], v1, s[28:31], s63 offen offset:256 nt
L_t_join:
s_waitcnt vmcnt(2)
buffer_load_dwordx4 v[160:163], v1, s[28:31], s64 offen offset:0 nt
s_waitcnt vmcnt(2)
buffer_load_dwordx4 v[164:167], v1, s[28:31], s64 offen offset:128 nt
s_waitcnt vmcnt(2)
buffer_load_dwordx4 v[168:171], v1, s[28:31], s64 offen offset:256 nt
s_waitcnt vmcnt(2)
buffer_load_dwordx4 v[172:175], v1, s[28:31], s65 offen offset:0 nt
s_waitcnt vmcnt(2)
buffer_load_dwordx4 v[176:179], v1, s[28:31], s65 offen offset:128 nt
s_waitcnt vmcnt(2)
buffer_load_dwordx4 v[180:183], v1, s[28:31], s65 offen offset:256 nt
s_waitcnt vmcnt(2)
buffer_load_dwordx4 v[184:187], v1, s[28:31], s66 offen offset:0 nt
s_waitcnt vmcnt(2)
buffer_load_dwordx4 v[188:191], v1, s[28:31], s66 offen offset:128 nt
s_waitcnt vmcnt(2)
buffer_load_dwordx4 v[192:195], v1, s[28:31], s66 offen offset:256 nt
s_waitcnt vmcnt(2)
buffer_load_dwordx4 v[196:199], v1, s[28:31], s67 offen offset:0 nt
s_waitcnt vmcnt(2)
buffer_load_dwordx4 v[200:203], v1, s[28:31], s67 offen offset:128 nt
s_waitcnt vmcnt(2)
buffer_load_dwordx4 v[204:207], v1, s[28:31], s67 offen offset:256 nt
v_mov_b32 v47, 0
s_mov_b32 s74, 0
L_spin_1:
ds_read_b32 v46, v47 offset:1728
s_waitcnt lgkmcnt(0)
v_readfirstlane_b32 s3, v46
s_add_u32 s74, s74, 1
s_nop 2
s_cmp_eq_u32 s3, 1
s_cbranch_scc1 L_spind_2
s_cmp_lt_u32 s74, 4000000
s_cbranch_scc0 L_spind_2
s_sleep 1
s_branch L_spin_1
L_spind_2:
v_and_b32 v46, 7, v0
v_lshlrev_b32 v46, 4, v46
ds_read_b128 v[4:7], v46 offset:0
ds_read_b128 v[8:11], v46 offset:128
ds_read_b128 v[12:15], v46 offset:256
ds_read_b32 v46, v47 offset:1744
s_waitcnt lgkmcnt(0)
v_readfirstlane_b32 s11, v46
s_waitcnt vmcnt(2)
buffer_load_dwordx4 v[208:211], v1, s[28:31], s68 offen offset:0 nt
v_dot2_f32_bf16 v16, v64, v4, 0
v_dot2_f32_bf16 v17, v76, v4, 0
v_dot2_f32_bf16 v16, v65, v5, v16
v_dot2_f32_bf16 v17, v77, v5, v17
v_dot2_f32_bf16 v16, v66, v6, v16
v_dot2_f32_bf16 v17, v78, v6, v17
v_dot2_f32_bf16 v16, v67, v7, v16
v_dot2_f32_bf16 v17, v79, v7, v17
v_dot2_f32_bf16 v16, v68, v8, v16
v_dot2_f32_bf16 v17, v80, v8, v17
v_dot2_f32_bf16 v16, v69, v9, v16
v_dot2_f32_bf16 v17, v81, v9, v17
v_dot2_f32_bf16 v16, v70, v10, v16
v_dot2_f32_bf16 v17, v82, v10, v17
v_dot2_f32_bf16 v16, v71, v11, v16
v_dot2_f32_bf16 v17, v83, v11, v17
v_dot2_f32_bf16 v16, v72, v12, v16
v_dot2_f32_bf16 v17, v84, v12, v17
v_dot2_f32_bf16 v16, v73, v13, v16
v_dot2_f32_bf16 v17, v85, v13, v17
v_dot2_f32_bf16 v16, v74, v14, v16
v_dot2_f32_bf16 v17, v86, v14, v17
v_dot2_f32_bf16 v16, v75, v15, v16
v_dot2_f32_bf16 v17, v87, v15, v17
s_nop 1
v_add_f32_dpp v16, v16, v16 quad_perm:[1,0,3,2] row_mask:0xf bank_mask:0xf
v_add_f32_dpp v17, v17, v17 quad_perm:[1,0,3,2] row_mask:0xf bank_mask:0xf
s_nop 0
v_add_f32_dpp v16, v16, v16 quad_perm:[2,3,0,1] row_mask:0xf bank_mask:0xf
v_add_f32_dpp v17, v17, v17 quad_perm:[2,3,0,1] row_mask:0xf bank_mask:0xf
s_nop 0
v_add_f32_dpp v16, v16, v16 row_half_mirror row_mask:0xf bank_mask:0xf
v_add_f32_dpp v17, v17, v17 row_half_mirror row_mask:0xf bank_mask:0xf
v_cvt_pk_bf16_f32 v44, v16, v17
v_lshlrev_b32 v45, 16, v44
v_and_b32 v46, 0xffff0000, v44
v_mul_f32 v45, 0x3d93cd3a, v45
v_mul_f32 v46, 0x3d93cd3a, v46
v_cvt_pk_bf16_f32 v44, v45, v46
v_lshlrev_b32 v16, 16, v44
v_and_b32 v17, 0xffff0000, v44
s_waitcnt vmcnt(2)
buffer_load_dwordx4 v[212:215], v1, s[28:31], s68 offen offset:128 nt
s_waitcnt vmcnt(2)
buffer_load_dwordx4 v[216:219], v1, s[28:31], s68 offen offset:256 nt
s_waitcnt vmcnt(2)
buffer_load_dwordx4 v[220:223], v1, s[28:31], s69 offen offset:0 nt
v_dot2_f32_bf16 v18, v88, v4, 0
v_dot2_f32_bf16 v19, v100, v4, 0
v_dot2_f32_bf16 v18, v89, v5, v18
v_dot2_f32_bf16 v19, v101, v5, v19
v_dot2_f32_bf16 v18, v90, v6, v18
v_dot2_f32_bf16 v19, v102, v6, v19
v_dot2_f32_bf16 v18, v91, v7, v18
v_dot2_f32_bf16 v19, v103, v7, v19
v_dot2_f32_bf16 v18, v92, v8, v18
v_dot2_f32_bf16 v19, v104, v8, v19
v_dot2_f32_bf16 v18, v93, v9, v18
v_dot2_f32_bf16 v19, v105, v9, v19
v_dot2_f32_bf16 v18, v94, v10, v18
v_dot2_f32_bf16 v19, v106, v10, v19
v_dot2_f32_bf16 v18, v95, v11, v18
v_dot2_f32_bf16 v19, v107, v11, v19
v_dot2_f32_bf16 v18, v96, v12, v18
v_dot2_f32_bf16 v19, v108, v12, v19
v_dot2_f32_bf16 v18, v97, v13, v18
v_dot2_f32_bf16 v19, v109, v13, v19
v_dot2_f32_bf16 v18, v98, v14, v18
v_dot2_f32_bf16 v19, v110, v14, v19
v_dot2_f32_bf16 v18, v99, v15, v18
v_dot2_f32_bf16 v19, v111, v15, v19
s_nop 1
v_add_f32_dpp v18, v18, v18 quad_perm:[1,0,3,2] row_mask:0xf bank_mask:0xf
v_add_f32_dpp v19, v19, v19 quad_perm:[1,0,3,2] row_mask:0xf bank_mask:0xf
s_nop 0
v_add_f32_dpp v18, v18, v18 quad_perm:[2,3,0,1] row_mask:0xf bank_mask:0xf
v_add_f32_dpp v19, v19, v19 quad_perm:[2,3,0,1] row_mask:0xf bank_mask:0xf
s_nop 0
v_add_f32_dpp v18, v18, v18 row_half_mirror row_mask:0xf bank_mask:0xf
v_add_f32_dpp v19, v19, v19 row_half_mirror row_mask:0xf bank_mask:0xf
v_cvt_pk_bf16_f32 v44, v18, v19
v_lshlrev_b32 v45, 16, v44
v_and_b32 v46, 0xffff0000, v44
v_mul_f32 v45, 0x3d93cd3a, v45
v_mul_f32 v46, 0x3d93cd3a, v46
v_cvt_pk_bf16_f32 v44, v45, v46
v_lshlrev_b32 v18, 16, v44
v_and_b32 v19, 0xffff0000, v44
s_waitcnt vmcnt(2)
buffer_load_dwordx4 v[224:227], v1, s[28:31], s69 offen offset:128 nt
s_waitcnt vmcnt(2)
buffer_load_dwordx4 v[228:231], v1, s[28:31], s69 offen offset:256 nt
s_waitcnt vmcnt(2)
buffer_load_dwordx4 v[232:235], v1, s[28:31], s70 offen offset:0 nt
v_dot2_f32_bf16 v20, v112, v4, 0
v_dot2_f32_bf16 v21, v124, v4, 0
v_dot2_f32_bf16 v20, v113, v5, v20
v_dot2_f32_bf16 v21, v125, v5, v21
v_dot2_f32_bf16 v20, v114, v6, v20
v_dot2_f32_bf16 v21, v126, v6, v21
v_dot2_f32_bf16 v20, v115, v7, v20
v_dot2_f32_bf16 v21, v127, v7, v21
v_dot2_f32_bf16 v20, v116, v8, v20
v_dot2_f32_bf16 v21, v128, v8, v21
v_dot2_f32_bf16 v20, v117, v9, v20
v_dot2_f32_bf16 v21, v129, v9, v21
v_dot2_f32_bf16 v20, v118, v10, v20
v_dot2_f32_bf16 v21, v130, v10, v21
v_dot2_f32_bf16 v20, v119, v11, v20
v_dot2_f32_bf16 v21, v131, v11, v21
v_dot2_f32_bf16 v20, v120, v12, v20
v_dot2_f32_bf16 v21, v132, v12, v21
v_dot2_f32_bf16 v20, v121, v13, v20
v_dot2_f32_bf16 v21, v133, v13, v21
v_dot2_f32_bf16 v20, v122, v14, v20
v_dot2_f32_bf16 v21, v134, v14, v21
v_dot2_f32_bf16 v20, v123, v15, v20
v_dot2_f32_bf16 v21, v135, v15, v21
s_nop 1
v_add_f32_dpp v20, v20, v20 quad_perm:[1,0,3,2] row_mask:0xf bank_mask:0xf
v_add_f32_dpp v21, v21, v21 quad_perm:[1,0,3,2] row_mask:0xf bank_mask:0xf
s_nop 0
v_add_f32_dpp v20, v20, v20 quad_perm:[2,3,0,1] row_mask:0xf bank_mask:0xf
v_add_f32_dpp v21, v21, v21 quad_perm:[2,3,0,1] row_mask:0xf bank_mask:0xf
s_nop 0
v_add_f32_dpp v20, v20, v20 row_half_mirror row_mask:0xf bank_mask:0xf
v_add_f32_dpp v21, v21, v21 row_half_mirror row_mask:0xf bank_mask:0xf
v_cvt_pk_bf16_f32 v44, v20, v21
v_lshlrev_b32 v45, 16, v44
v_and_b32 v46, 0xffff0000, v44
v_mul_f32 v45, 0x3d93cd3a, v45
v_mul_f32 v46, 0x3d93cd3a, v46
v_cvt_pk_bf16_f32 v44, v45, v46
v_lshlrev_b32 v20, 16, v44
v_and_b32 v21, 0xffff0000, v44
s_waitcnt vmcnt(2)
buffer_load_dwordx4 v[236:239], v1, s[28:31], s70 offen offset:128 nt
s_waitcnt vmcnt(2)
buffer_load_dwordx4 v[240:243], v1, s[28:31], s70 offen offset:256 nt
s_waitcnt vmcnt(2)
buffer_load_dwordx4 v[244:247], v1, s[28:31], s71 offen offset:0 nt
v_dot2_f32_bf16 v22, v136, v4, 0
v_dot2_f32_bf16 v23, v148, v4, 0
v_dot2_f32_bf16 v22, v137, v5, v22
v_dot2_f32_bf16 v23, v149, v5, v23
v_dot2_f32_bf16 v22, v138, v6, v22
v_dot2_f32_bf16 v23, v150, v6, v23
v_dot2_f32_bf16 v22, v139, v7, v22
v_dot2_f32_bf16 v23, v151, v7, v23
v_dot2_f32_bf16 v22, v140, v8, v22
v_dot2_f32_bf16 v23, v152, v8, v23
v_dot2_f32_bf16 v22, v141, v9, v22
v_dot2_f32_bf16 v23, v153, v9, v23
v_dot2_f32_bf16 v22, v142, v10, v22
v_dot2_f32_bf16 v23, v154, v10, v23
v_dot2_f32_bf16 v22, v143, v11, v22
v_dot2_f32_bf16 v23, v155, v11, v23
v_dot2_f32_bf16 v22, v144, v12, v22
v_dot2_f32_bf16 v23, v156, v12, v23
v_dot2_f32_bf16 v22, v145, v13, v22
v_dot2_f32_bf16 v23, v157, v13, v23
v_dot2_f32_bf16 v22, v146, v14, v22
v_dot2_f32_bf16 v23, v158, v14, v23
v_dot2_f32_bf16 v22, v147, v15, v22
v_dot2_f32_bf16 v23, v159, v15, v23
s_nop 1
v_add_f32_dpp v22, v22, v22 quad_perm:[1,0,3,2] row_mask:0xf bank_mask:0xf
v_add_f32_dpp v23, v23, v23 quad_perm:[1,0,3,2] row_mask:0xf bank_mask:0xf
s_nop 0
v_add_f32_dpp v22, v22, v22 quad_perm:[2,3,0,1] row_mask:0xf bank_mask:0xf
v_add_f32_dpp v23, v23, v23 quad_perm:[2,3,0,1] row_mask:0xf bank_mask:0xf
s_nop 0
v_add_f32_dpp v22, v22, v22 row_half_mirror row_mask:0xf bank_mask:0xf
v_add_f32_dpp v23, v23, v23 row_half_mirror row_mask:0xf bank_mask:0xf
v_cvt_pk_bf16_f32 v44, v22, v23
v_lshlrev_b32 v45, 16, v44
v_and_b32 v46, 0xffff0000, v44
v_mul_f32 v45, 0x3d93cd3a, v45
v_mul_f32 v46, 0x3d93cd3a, v46
v_cvt_pk_bf16_f32 v44, v45, v46
v_lshlrev_b32 v22, 16, v44
v_and_b32 v23, 0xffff0000, v44
s_waitcnt vmcnt(2)
buffer_load_dwordx4 v[248:251], v1, s[28:31], s71 offen offset:128 nt
s_waitcnt vmcnt(2)
buffer_load_dwordx4 v[252:255], v1, s[28:31], s71 offen offset:256 nt
L_codewarm_from:
s_waitcnt vmcnt(2)
buffer_load_dwordx4 v[64:67], v1, s[32:35], s56 offen offset:0 nt
v_dot2_f32_bf16 v24, v160, v4, 0
v_dot2_f32_bf16 v25, v172, v4, 0
v_dot2_f32_bf16 v24, v161, v5, v24
v_dot2_f32_bf16 v25, v173, v5, v25
v_dot2_f32_bf16 v24, v162, v6, v24
v_dot2_f32_bf16 v25, v174, v6, v25
v_dot2_f32_bf16 v24, v163, v7, v24
v_dot2_f32_bf16 v25, v175, v7, v25
v_dot2_f32_bf16 v24, v164, v8, v24
v_dot2_f32_bf16 v25, v176, v8, v25
v_dot2_f32_bf16 v24, v165, v9, v24
v_dot2_f32_bf16 v25, v177, v9, v25
v_dot2_f32_bf16 v24, v166, v10, v24
v_dot2_f32_bf16 v25, v178, v10, v25
v_dot2_f32_bf16 v24, v167, v11, v24
v_dot2_f32_bf16 v25, v179, v11, v25
v_dot2_f32_bf16 v24, v168, v12, v24
v_dot2_f32_bf16 v25, v180, v12, v25
v_dot2_f32_bf16 v24, v169, v13, v24
v_dot2_f32_bf16 v25, v181, v13, v25
v_dot2_f32_bf16 v24, v170, v14, v24
v_dot2_f32_bf16 v25, v182, v14, v25
v_dot2_f32_bf16 v24, v171, v15, v24
v_dot2_f32_bf16 v25, v183, v15, v25
s_nop 1
v_add_f32_dpp v24, v24, v24 quad_perm:[1,0,3,2] row_mask:0xf bank_mask:0xf
v_add_f32_dpp v25, v25, v25 quad_perm:[1,0,3,2] row_mask:0xf bank_mask:0xf
s_nop 0
v_add_f32_dpp v24, v24, v24 quad_perm:[2,3,0,1] row_mask:0xf bank_mask:0xf
v_add_f32_dpp v25, v25, v25 quad_perm:[2,3,0,1] row_mask:0xf bank_mask:0xf
s_nop 0
v_add_f32_dpp v24, v24, v24 row_half_mirror row_mask:0xf bank_mask:0xf
v_add_f32_dpp v25, v25, v25 row_half_mirror row_mask:0xf bank_mask:0xf
v_cvt_pk_bf16_f32 v44, v24, v25
v_lshlrev_b32 v45, 16, v44
v_and_b32 v46, 0xffff0000, v44
v_mul_f32 v45, 0x3d93cd3a, v45
v_mul_f32 v46, 0x3d93cd3a, v46
v_cvt_pk_bf16_f32 v44, v45, v46
v_lshlrev_b32 v24, 16, v44
v_and_b32 v25, 0xffff0000, v44
s_waitcnt vmcnt(2)
buffer_load_dwordx4 v[68:71], v1, s[32:35], s56 offen offset:128 nt
s_waitcnt vmcnt(2)
buffer_load_dwordx4 v[72:75], v1, s[32:35], s56 offen offset:256 nt
s_waitcnt vmcnt(2)
buffer_load_dwordx4 v[76:79], v1, s[32:35], s57 offen offset:0 nt
v_dot2_f32_bf16 v26, v184, v4, 0
v_dot2_f32_bf16 v27, v196, v4, 0
v_dot2_f32_bf16 v26, v185, v5, v26
v_dot2_f32_bf16 v27, v197, v5, v27
v_dot2_f32_bf16 v26, v186, v6, v26
v_dot2_f32_bf16 v27, v198, v6, v27
v_dot2_f32_bf16 v26, v187, v7, v26
v_dot2_f32_bf16 v27, v199, v7, v27
v_dot2_f32_bf16 v26, v188, v8, v26
v_dot2_f32_bf16 v27, v200, v8, v27
v_dot2_f32_bf16 v26, v189, v9, v26
v_dot2_f32_bf16 v27, v201, v9, v27
v_dot2_f32_bf16 v26, v190, v10, v26
v_dot2_f32_bf16 v27, v202, v10, v27
v_dot2_f32_bf16 v26, v191, v11, v26
v_dot2_f32_bf16 v27, v203, v11, v27
v_dot2_f32_bf16 v26, v192, v12, v26
v_dot2_f32_bf16 v27, v204, v12, v27
v_dot2_f32_bf16 v26, v193, v13, v26
v_dot2_f32_bf16 v27, v205, v13, v27
v_dot2_f32_bf16 v26, v194, v14, v26
v_dot2_f32_bf16 v27, v206, v14, v27
v_dot2_f32_bf16 v26, v195, v15, v26
v_dot2_f32_bf16 v27, v207, v15, v27
s_nop 1
v_add_f32_dpp v26, v26, v26 quad_perm:[1,0,3,2] row_mask:0xf bank_mask:0xf
v_add_f32_dpp v27, v27, v27 quad_perm:[1,0,3,2] row_mask:0xf bank_mask:0xf
s_nop 0
v_add_f32_dpp v26, v26, v26 quad_perm:[2,3,0,1] row_mask:0xf bank_mask:0xf
v_add_f32_dpp v27, v27, v27 quad_perm:[2,3,0,1] row_mask:0xf bank_mask:0xf
s_nop 0
v_add_f32_dpp v26, v26, v26 row_half_mirror row_mask:0xf bank_mask:0xf
v_add_f32_dpp v27, v27, v27 row_half_mirror row_mask:0xf bank_mask:0xf
v_cvt_pk_bf16_f32 v44, v26, v27
v_lshlrev_b32 v45, 16, v44
v_and_b32 v46, 0xffff0000, v44
v_mul_f32 v45, 0x3d93cd3a, v45
v_mul_f32 v46, 0x3d93cd3a, v46
v_cvt_pk_bf16_f32 v44, v45, v46
v_lshlrev_b32 v26, 16, v44
v_and_b32 v27, 0xffff0000, v44
s_waitcnt vmcnt(2)
buffer_load_dwordx4 v[80:83], v1, s[32:35], s57 offen offset:128 nt
s_waitcnt vmcnt(2)
buffer_load_dwordx4 v[84:87], v1, s[32:35], s57 offen offset:256 nt
s_waitcnt vmcnt(2)
buffer_load_dwordx4 v[88:91], v1, s[32:35], s58 offen offset:0 nt
v_dot2_f32_bf16 v28, v208, v4, 0
v_dot2_f32_bf16 v29, v220, v4, 0
v_dot2_f32_bf16 v28, v209, v5, v28
v_dot2_f32_bf16 v29, v221, v5, v29
v_dot2_f32_bf16 v28, v210, v6, v28
v_dot2_f32_bf16 v29, v222, v6, v29
v_dot2_f32_bf16 v28, v211, v7, v28
v_dot2_f32_bf16 v29, v223, v7, v29
v_dot2_f32_bf16 v28, v212, v8, v28
v_dot2_f32_bf16 v29, v224, v8, v29
v_dot2_f32_bf16 v28, v213, v9, v28
v_dot2_f32_bf16 v29, v225, v9, v29
v_dot2_f32_bf16 v28, v214, v10, v28
v_dot2_f32_bf16 v29, v226, v10, v29
v_dot2_f32_bf16 v28, v215, v11, v28
v_dot2_f32_bf16 v29, v227, v11, v29
v_dot2_f32_bf16 v28, v216, v12, v28
v_dot2_f32_bf16 v29, v228, v12, v29
v_dot2_f32_bf16 v28, v217, v13, v28
v_dot2_f32_bf16 v29, v229, v13, v29
v_dot2_f32_bf16 v28, v218, v14, v28
v_dot2_f32_bf16 v29, v230, v14, v29
v_dot2_f32_bf16 v28, v219, v15, v28
v_dot2_f32_bf16 v29, v231, v15, v29
s_nop 1
v_add_f32_dpp v28, v28, v28 quad_perm:[1,0,3,2] row_mask:0xf bank_mask:0xf
v_add_f32_dpp v29, v29, v29 quad_perm:[1,0,3,2] row_mask:0xf bank_mask:0xf
s_nop 0
v_add_f32_dpp v28, v28, v28 quad_perm:[2,3,0,1] row_mask:0xf bank_mask:0xf
v_add_f32_dpp v29, v29, v29 quad_perm:[2,3,0,1] row_mask:0xf bank_mask:0xf
s_nop 0
v_add_f32_dpp v28, v28, v28 row_half_mirror row_mask:0xf bank_mask:0xf
v_add_f32_dpp v29, v29, v29 row_half_mirror row_mask:0xf bank_mask:0xf
v_cvt_pk_bf16_f32 v44, v28, v29
v_lshlrev_b32 v45, 16, v44
v_and_b32 v46, 0xffff0000, v44
v_mul_f32 v45, 0x3d93cd3a, v45
v_mul_f32 v46, 0x3d93cd3a, v46
v_cvt_pk_bf16_f32 v44, v45, v46
v_lshlrev_b32 v28, 16, v44
v_and_b32 v29, 0xffff0000, v44
s_waitcnt vmcnt(2)
buffer_load_dwordx4 v[92:95], v1, s[32:35], s58 offen offset:128 nt
s_waitcnt vmcnt(2)
buffer_load_dwordx4 v[96:99], v1, s[32:35], s58 offen offset:256 nt
s_waitcnt vmcnt(2)
buffer_load_dwordx4 v[100:103], v1, s[32:35], s59 offen offset:0 nt
v_dot2_f32_bf16 v30, v232, v4, 0
v_dot2_f32_bf16 v31, v244, v4, 0
v_dot2_f32_bf16 v30, v233, v5, v30
v_dot2_f32_bf16 v31, v245, v5, v31
v_dot2_f32_bf16 v30, v234, v6, v30
v_dot2_f32_bf16 v31, v246, v6, v31
v_dot2_f32_bf16 v30, v235, v7, v30
v_dot2_f32_bf16 v31, v247, v7, v31
v_dot2_f32_bf16 v30, v236, v8, v30
v_dot2_f32_bf16 v31, v248, v8, v31
v_dot2_f32_bf16 v30, v237, v9, v30
v_dot2_f32_bf16 v31, v249, v9, v31
v_dot2_f32_bf16 v30, v238, v10, v30
v_dot2_f32_bf16 v31, v250, v10, v31
v_dot2_f32_bf16 v30, v239, v11, v30
v_dot2_f32_bf16 v31, v251, v11, v31
v_dot2_f32_bf16 v30, v240, v12, v30
v_dot2_f32_bf16 v31, v252, v12, v31
v_dot2_f32_bf16 v30, v241, v13, v30
v_dot2_f32_bf16 v31, v253, v13, v31
v_dot2_f32_bf16 v30, v242, v14, v30
v_dot2_f32_bf16 v31, v254, v14, v31
v_dot2_f32_bf16 v30, v243, v15, v30
v_dot2_f32_bf16 v31, v255, v15, v31
s_nop 1
v_add_f32_dpp v30, v30, v30 quad_perm:[1,0,3,2] row_mask:0xf bank_mask:0xf
v_add_f32_dpp v31, v31, v31 quad_perm:[1,0,3,2] row_mask:0xf bank_mask:0xf
s_nop 0
v_add_f32_dpp v30, v30, v30 quad_perm:[2,3,0,1] row_mask:0xf bank_mask:0xf
v_add_f32_dpp v31, v31, v31 quad_perm:[2,3,0,1] row_mask:0xf bank_mask:0xf
s_nop 0
v_add_f32_dpp v30, v30, v30 row_half_mirror row_mask:0xf bank_mask:0xf
v_add_f32_dpp v31, v31, v31 row_half_mirror row_mask:0xf bank_mask:0xf
v_cvt_pk_bf16_f32 v44, v30, v31
v_lshlrev_b32 v45, 16, v44
v_and_b32 v46, 0xffff0000, v44
v_mul_f32 v45, 0x3d93cd3a, v45
v_mul_f32 v46, 0x3d93cd3a, v46
v_cvt_pk_bf16_f32 v44, v45, v46
v_lshlrev_b32 v30, 16, v44
v_and_b32 v31, 0xffff0000, v44
s_waitcnt vmcnt(2)
buffer_load_dwordx4 v[104:107], v1, s[32:35], s59 offen offset:128 nt
s_waitcnt vmcnt(2)
buffer_load_dwordx4 v[108:111], v1, s[32:35], s59 offen offset:256 nt
s_waitcnt vmcnt(2)
buffer_load_dwordx4 v[112:115], v1, s[32:35], s60 offen offset:0 nt
v_max3_f32 v44, v16, v17, v18
v_max3_f32 v44, v44, v19, v20
v_max3_f32 v44, v44, v21, v22
v_max3_f32 v44, v44, v23, v24
v_max3_f32 v44, v44, v25, v26
v_max3_f32 v44, v44, v27, v28
v_max3_f32 v44, v44, v29, v30
v_max_f32 v44, v44, v31
s_nop 1
v_max_f32_dpp v44, v44, v44 row_ror:8 row_mask:0xf bank_mask:0xf
v_mov_b32 v45, v44
s_nop 1
v_permlane16_swap_b32 v44, v45
s_nop 0
v_max_f32 v44, v44, v45
v_mov_b32 v45, v44
s_nop 1
v_permlane32_swap_b32 v44, v45
s_nop 0
v_max_f32 v44, v44, v45
v_mov_b32 v61, v44
v_mov_b32 v45, 0
v_mov_b32 v46, 1
s_mov_b64 exec, 1
ds_max_f32 v45, v44 offset:1736
ds_add_u32 v45, v46 offset:1732
s_mov_b64 exec, -1
s_mov_b32 s72, 0x3fb8aa3b
v_mul_f32 v45, s72, v61
v_fma_f32 v16, v16, s72, -v45
v_fma_f32 v17, v17, s72, -v45
v_fma_f32 v18, v18, s72, -v45
v_fma_f32 v19, v19, s72, -v45
v_fma_f32 v20, v20, s72, -v45
v_fma_f32 v21, v21, s72, -v45
v_fma_f32 v22, v22, s72, -v45
v_fma_f32 v23, v23, s72, -v45
v_fma_f32 v24, v24, s72, -v45
v_fma_f32 v25, v25, s72, -v45
v_fma_f32 v26, v26, s72, -v45
v_fma_f32 v27, v27, s72, -v45
v_fma_f32 v28, v28, s72, -v45
v_fma_f32 v29, v29, s72, -v45
v_fma_f32 v30, v30, s72, -v45
v_fma_f32 v31, v31, s72, -v45
v_exp_f32 v16, v16
v_exp_f32 v17, v17
v_exp_f32 v18, v18
v_exp_f32 v19, v19
v_exp_f32 v20, v20
v_exp_f32 v21, v21
v_exp_f32 v22, v22
v_exp_f32 v23, v23
v_exp_f32 v24, v24
v_exp_f32 v25, v25
v_exp_f32 v26, v26
v_exp_f32 v27, v27
v_exp_f32 v28, v28
v_exp_f32 v29, v29
v_exp_f32 v30, v30
v_exp_f32 v31, v31
s_waitcnt vmcnt(2)
buffer_load_dwordx4 v[116:119], v1, s[32:35], s60 offen offset:128 nt
v_add_f32 v60, v16, v17
v_add_f32 v60, v60, v18
v_add_f32 v60, v60, v19
v_add_f32 v60, v60, v20
v_add_f32 v60, v60, v21
v_add_f32 v60, v60, v22
v_add_f32 v60, v60, v23
v_add_f32 v60, v60, v24
v_add_f32 v60, v60, v25
v_add_f32 v60, v60, v26
v_add_f32 v60, v60, v27
v_add_f32 v60, v60, v28
v_add_f32 v60, v60, v29
v_add_f32 v60, v60, v30
v_add_f32 v60, v60, v31
v_cvt_pk_bf16_f32 v16, v16, v16
v_cvt_pk_bf16_f32 v17, v17, v17
v_cvt_pk_bf16_f32 v18, v18, v18
v_cvt_pk_bf16_f32 v19, v19, v19
v_cvt_pk_bf16_f32 v20, v20, v20
v_cvt_pk_bf16_f32 v21, v21, v21
v_cvt_pk_bf16_f32 v22, v22, v22
v_cvt_pk_bf16_f32 v23, v23, v23
v_cvt_pk_bf16_f32 v24, v24, v24
v_cvt_pk_bf16_f32 v25, v25, v25
v_cvt_pk_bf16_f32 v26, v26, v26
v_cvt_pk_bf16_f32 v27, v27, v27
v_cvt_pk_bf16_f32 v28, v28, v28
v_cvt_pk_bf16_f32 v29, v29, v29
v_cvt_pk_bf16_f32 v30, v30, v30
v_cvt_pk_bf16_f32 v31, v31, v31
s_nop 1
v_add_f32_dpp v60, v60, v60 row_ror:8 row_mask:0xf bank_mask:0xf
v_mov_b32 v47, v60
s_nop 1
v_permlane16_swap_b32 v60, v47
s_nop 0
v_add_f32 v60, v60, v47
v_mov_b32 v47, v60
s_nop 1
v_permlane32_swap_b32 v60, v47
s_nop 0
v_add_f32 v60, v60, v47
s_waitcnt vmcnt(2)
buffer_load_dwordx4 v[120:123], v1, s[32:35], s60 offen offset:256 nt
s_waitcnt vmcnt(2)
buffer_load_dwordx4 v[124:127], v1, s[32:35], s61 offen offset:0 nt
s_waitcnt vmcnt(2)
buffer_load_dwordx4 v[128:131], v1, s[32:35], s61 offen offset:128 nt
v_and_b32 v32, v16, v40
v_and_b32 v33, v16, v41
v_and_b32 v34, v16, v42
v_and_b32 v35, v16, v43
s_nop 1
v_mfma_f32_16x16x32_bf16 v[4:7], v[64:67], v[32:35], 0
v_mfma_f32_16x16x32_bf16 v[8:11], v[68:71], v[32:35], 0
v_mfma_f32_16x16x32_bf16 v[12:15], v[72:75], v[32:35], 0
v_and_b32 v36, v17, v40
v_and_b32 v37, v17, v41
v_and_b32 v38, v17, v42
v_and_b32 v39, v17, v43
s_nop 1
v_mfma_f32_16x16x32_bf16 v[4:7], v[76:79], v[36:39], v[4:7]
v_mfma_f32_16x16x32_bf16 v[8:11], v[80:83], v[36:39], v[8:11]
v_mfma_f32_16x16x32_bf16 v[12:15], v[84:87], v[36:39], v[12:15]
s_waitcnt vmcnt(2)
buffer_load_dwordx4 v[132:135], v1, s[32:35], s61 offen offset:256 nt
s_cmp_eq_u32 s48, 1
s_cbranch_scc0 L_f_norm
s_cmp_ge_u32 s2, 192
s_cbranch_scc1 L_f_zero
s_lshr_b32 s3, s2, 3
s_mul_i32 s3, s3, 2560
s_and_b32 s72, s2, 7
s_lshl_b32 s72, s72, 5
s_add_u32 s3, s3, s72
s_add_u32 s3, s3, 794624
v_bfe_u32 v44, v0, 2, 1
v_mul_u32_u24 v44, 61440, v44
v_bfe_u32 v45, v0, 1, 1
v_lshl_add_u32 v44, v45, 8, v44
v_and_b32 v45, 1, v0
v_lshl_add_u32 v44, v45, 4, v44
v_add_u32 v180, s3, v44
buffer_load_dwordx4 v[160:163], v180, s[36:39], 0 offen offset:0 sc1
buffer_load_dwordx4 v[164:167], v180, s[36:39], 0 offen offset:512 sc1
buffer_load_dwordx4 v[168:171], v180, s[36:39], 0 offen offset:1024 sc1
buffer_load_dwordx4 v[172:175], v180, s[36:39], 0 offen offset:1536 sc1
buffer_load_dwordx4 v[176:179], v180, s[36:39], 0 offen offset:2048 sc1
s_waitcnt vmcnt(7)
buffer_load_dwordx4 v[136:139], v1, s[32:35], s62 offen offset:0 nt
s_waitcnt vmcnt(7)
buffer_load_dwordx4 v[140:143], v1, s[32:35], s62 offen offset:128 nt
v_and_b32 v32, v18, v40
v_and_b32 v33, v18, v41
v_and_b32 v34, v18, v42
v_and_b32 v35, v18, v43
s_nop 1
v_mfma_f32_16x16x32_bf16 v[4:7], v[88:91], v[32:35], v[4:7]
v_mfma_f32_16x16x32_bf16 v[8:11], v[92:95], v[32:35], v[8:11]
v_mfma_f32_16x16x32_bf16 v[12:15], v[96:99], v[32:35], v[12:15]
v_and_b32 v36, v19, v40
v_and_b32 v37, v19, v41
v_and_b32 v38, v19, v42
v_and_b32 v39, v19, v43
s_nop 1
v_mfma_f32_16x16x32_bf16 v[4:7], v[100:103], v[36:39], v[4:7]
v_mfma_f32_16x16x32_bf16 v[8:11], v[104:107], v[36:39], v[8:11]
v_mfma_f32_16x16x32_bf16 v[12:15], v[108:111], v[36:39], v[12:15]
s_waitcnt vmcnt(7)
buffer_load_dwordx4 v[144:147], v1, s[32:35], s62 offen offset:256 nt
s_waitcnt vmcnt(3)
s_mov_b32 s74, 0
v_xor_b32 v160, v160, v63
v_xor_b32 v161, v161, v63
v_xor_b32 v162, v162, v63
v_xor_b32 v163, v163, v63
v_xor_b32 v164, v164, v63
v_xor_b32 v165, v165, v63
v_xor_b32 v166, v166, v63
v_xor_b32 v167, v167, v63
v_xor_b32 v168, v168, v63
v_xor_b32 v169, v169, v63
v_xor_b32 v170, v170, v63
v_xor_b32 v171, v171, v63
v_xor_b32 v172, v172, v63
v_xor_b32 v173, v173, v63
v_xor_b32 v174, v174, v63
v_xor_b32 v175, v175, v63
v_xor_b32 v176, v176, v63
v_xor_b32 v177, v177, v63
v_xor_b32 v178, v178, v63
v_xor_b32 v179, v179, v63
v_or3_b32 v45, v160, v161, v162
v_or3_b32 v45, v45, v163, v164
v_or3_b32 v45, v45, v165, v166
v_or3_b32 v45, v45, v167, v168
v_or3_b32 v45, v45, v169, v170
v_or3_b32 v45, v45, v171, v172
v_or3_b32 v45, v45, v173, v174
v_or3_b32 v45, v45, v175, v176
v_or3_b32 v45, v45, v177, v178
v_or_b32 v45, v45, v179
v_and_b32 v45, 0x3ff, v45
v_cmp_ne_u32 vcc, 0, v45
s_add_u32 s74, s74, 1
s_nop 3
s_cmp_eq_u64 vcc, 0
s_cbranch_scc1 L_fok
L_fpoll:
s_sleep 2
buffer_load_dwordx4 v[160:163], v180, s[36:39], 0 offen offset:0 sc1
buffer_load_dwordx4 v[164:167], v180, s[36:39], 0 offen offset:512 sc1
buffer_load_dwordx4 v[168:171], v180, s[36:39], 0 offen offset:1024 sc1
buffer_load_dwordx4 v[172:175], v180, s[36:39], 0 offen offset:1536 sc1
buffer_load_dwordx4 v[176:179], v180, s[36:39], 0 offen offset:2048 sc1
s_waitcnt vmcnt(0)
v_xor_b32 v160, v160, v63
v_xor_b32 v161, v161, v63
v_xor_b32 v162, v162, v63
v_xor_b32 v163, v163, v63
v_xor_b32 v164, v164, v63
v_xor_b32 v165, v165, v63
v_xor_b32 v166, v166, v63
v_xor_b32 v167, v167, v63
v_xor_b32 v168, v168, v63
v_xor_b32 v169, v169, v63
v_xor_b32 v170, v170, v63
v_xor_b32 v171, v171, v63
v_xor_b32 v172, v172, v63
v_xor_b32 v173, v173, v63
v_xor_b32 v174, v174, v63
v_xor_b32 v175, v175, v63
v_xor_b32 v176, v176, v63
v_xor_b32 v177, v177, v63
v_xor_b32 v178, v178, v63
v_xor_b32 v179, v179, v63
v_or3_b32 v45, v160, v161, v162
v_or3_b32 v45, v45, v163, v164
v_or3_b32 v45, v45, v165, v166
v_or3_b32 v45, v45, v167, v168
v_or3_b32 v45, v45, v169, v170
v_or3_b32 v45, v45, v171, v172
v_or3_b32 v45, v45, v173, v174
v_or3_b32 v45, v45, v175, v176
v_or3_b32 v45, v45, v177, v178
v_or_b32 v45, v45, v179
v_and_b32 v45, 0x3ff, v45
v_cmp_ne_u32 vcc, 0, v45
s_add_u32 s74, s74, 1
s_nop 3
s_cmp_eq_u64 vcc, 0
s_cbranch_scc1 L_fok
s_cmp_lt_u32 s74, 200000
s_cbranch_scc1 L_fpoll
v_mov_b32 v46, 258
v_mov_b32 v47, 4
global_store_dword v47, v46, s[24:25]
L_fok:
v_add_f32 v160, v160, v164
v_add_f32 v160, v160, v168
v_add_f32 v160, v160, v172
v_add_f32 v160, v160, v176
v_add_f32 v161, v161, v165
v_add_f32 v161, v161, v169
v_add_f32 v161, v161, v173
v_add_f32 v161, v161, v177
v_add_f32 v162, v162, v166
v_add_f32 v162, v162, v170
v_add_f32 v162, v162, v174
v_add_f32 v162, v162, v178
v_add_f32 v163, v163, v167
v_add_f32 v163, v163, v171
v_add_f32 v163, v163, v175
v_add_f32 v163, v163, v179
v_cvt_pk_bf16_f32 v164, v160, v161
v_cvt_pk_bf16_f32 v165, v162, v163
v_lshlrev_b32 v160, 16, v164
v_and_b32 v161, 0xffff0000, v164
v_lshlrev_b32 v162, 16, v165
v_and_b32 v163, 0xffff0000, v165
v_mul_f32 v168, 0xbfb8aa3b, v160
v_mul_f32 v169, 0xbfb8aa3b, v161
v_mul_f32 v170, 0xbfb8aa3b, v162
v_mul_f32 v171, 0xbfb8aa3b, v163
v_exp_f32 v168, v168
v_exp_f32 v169, v169
v_exp_f32 v170, v170
v_exp_f32 v171, v171
v_mov_b32_dpp v172, v160 row_ror:4 row_mask:0xf bank_mask:0xf
v_mov_b32_dpp v173, v161 row_ror:4 row_mask:0xf bank_mask:0xf
v_mov_b32_dpp v174, v162 row_ror:4 row_mask:0xf bank_mask:0xf
v_mov_b32_dpp v175, v163 row_ror:4 row_mask:0xf bank_mask:0xf
v_add_f32 v168, 1.0, v168
v_add_f32 v169, 1.0, v169
v_add_f32 v170, 1.0, v170
v_add_f32 v171, 1.0, v171
v_rcp_f32 v168, v168
v_rcp_f32 v169, v169
v_rcp_f32 v170, v170
v_rcp_f32 v171, v171
s_nop 0
v_mul_f32 v168, v160, v168
v_mul_f32 v169, v161, v169
v_mul_f32 v170, v162, v170
v_mul_f32 v171, v163, v171
v_cvt_pk_bf16_f32 v164, v168, v169
v_cvt_pk_bf16_f32 v165, v170, v171
v_lshlrev_b32 v168, 16, v164
v_and_b32 v169, 0xffff0000, v164
v_lshlrev_b32 v170, 16, v165
v_and_b32 v171, 0xffff0000, v165
v_mul_f32 v168, v168, v172
v_mul_f32 v169, v169, v173
v_mul_f32 v170, v170, v174
v_mul_f32 v171, v171, v175
v_cvt_pk_bf16_f32 v164, v168, v169
v_cvt_pk_bf16_f32 v165, v170, v171
v_bfe_u32 v44, v0, 1, 1
v_lshlrev_b32 v44, 6, v44
v_and_b32 v45, 1, v0
v_lshl_add_u32 v44, v45, 3, v44
s_mov_b64 exec, 0x0f
ds_write_b64 v44, v[164:165] offset:1584
s_mov_b64 exec, -1
s_branch L_f_join
L_f_zero:
v_mov_b32 v164, 0
v_mov_b32 v165, 0
v_bfe_u32 v44, v0, 1, 1
v_lshlrev_b32 v44, 6, v44
v_and_b32 v45, 1, v0
v_lshl_add_u32 v44, v45, 3, v44
s_mov_b64 exec, 0x0f
ds_write_b64 v44, v[164:165] offset:1584
s_mov_b64 exec, -1
L_f_norm:
s_waitcnt vmcnt(2)
buffer_load_dwordx4 v[136:139], v1, s[32:35], s62 offen offset:0 nt
s_waitcnt vmcnt(2)
buffer_load_dwordx4 v[140:143], v1, s[32:35], s62 offen offset:128 nt
v_and_b32 v32, v18, v40
v_and_b32 v33, v18, v41
v_and_b32 v34, v18, v42
v_and_b32 v35, v18, v43
s_nop 1
v_mfma_f32_16x16x32_bf16 v[4:7], v[88:91], v[32:35], v[4:7]
v_mfma_f32_16x16x32_bf16 v[8:11], v[92:95], v[32:35], v[8:11]
v_mfma_f32_16x16x32_bf16 v[12:15], v[96:99], v[32:35], v[12:15]
v_and_b32 v36, v19, v40
v_and_b32 v37, v19, v41
v_and_b32 v38, v19, v42
v_and_b32 v39, v19, v43
s_nop 1
v_mfma_f32_16x16x32_bf16 v[4:7], v[100:103], v[36:39], v[4:7]
v_mfma_f32_16x16x32_bf16 v[8:11], v[104:107], v[36:39], v[8:11]
v_mfma_f32_16x16x32_bf16 v[12:15], v[108:111], v[36:39], v[12:15]
s_waitcnt vmcnt(2)
buffer_load_dwordx4 v[144:147], v1, s[32:35], s62 offen offset:256 nt
L_f_join:
s_waitcnt vmcnt(2)
buffer_load_dwordx4 v[148:151], v1, s[32:35], s63 offen offset:0 nt
s_waitcnt vmcnt(2)
buffer_load_dwordx4 v[152:155], v1, s[32:35], s63 offen offset:128 nt
v_and_b32 v32, v20, v40
v_and_b32 v33, v20, v41
v_and_b32 v34, v20, v42
v_and_b32 v35, v20, v43
s_nop 1
v_mfma_f32_16x16x32_bf16 v[4:7], v[112:115], v[32:35], v[4:7]
v_mfma_f32_16x16x32_bf16 v[8:11], v[116:119], v[32:35], v[8:11]
v_mfma_f32_16x16x32_bf16 v[12:15], v[120:123], v[32:35], v[12:15]
v_and_b32 v36, v21, v40
v_and_b32 v37, v21, v41
v_and_b32 v38, v21, v42
v_and_b32 v39, v21, v43
s_nop 1
v_mfma_f32_16x16x32_bf16 v[4:7], v[124:127], v[36:39], v[4:7]
v_mfma_f32_16x16x32_bf16 v[8:11], v[128:131], v[36:39], v[8:11]
v_mfma_f32_16x16x32_bf16 v[12:15], v[132:135], v[36:39], v[12:15]
s_waitcnt vmcnt(2)
buffer_load_dwordx4 v[156:159], v1, s[32:35], s63 offen offset:256 nt
s_waitcnt vmcnt(2)
buffer_load_dwordx4 v[160:163], v1, s[32:35], s64 offen offset:0 nt
s_waitcnt vmcnt(2)
buffer_load_dwordx4 v[164:167], v1, s[32:35], s64 offen offset:128 nt
v_and_b32 v32, v22, v40
v_and_b32 v33, v22, v41
v_and_b32 v34, v22, v42
v_and_b32 v35, v22, v43
s_nop 1
v_mfma_f32_16x16x32_bf16 v[4:7], v[136:139], v[32:35], v[4:7]
v_mfma_f32_16x16x32_bf16 v[8:11], v[140:143], v[32:35], v[8:11]
v_mfma_f32_16x16x32_bf16 v[12:15], v[144:147], v[32:35], v[12:15]
s_waitcnt vmcnt(2)
buffer_load_dwordx4 v[168:171], v1, s[32:35], s64 offen offset:256 nt
s_waitcnt vmcnt(2)
buffer_load_dwordx4 v[172:175], v1, s[32:35], s65 offen offset:0 nt
s_waitcnt vmcnt(2)
buffer_load_dwordx4 v[176:179], v1, s[32:35], s65 offen offset:128 nt
v_and_b32 v36, v23, v40
v_and_b32 v37, v23, v41
v_and_b32 v38, v23, v42
v_and_b32 v39, v23, v43
s_nop 1
v_mfma_f32_16x16x32_bf16 v[4:7], v[148:151], v[36:39], v[4:7]
v_mfma_f32_16x16x32_bf16 v[8:11], v[152:155], v[36:39], v[8:11]
v_mfma_f32_16x16x32_bf16 v[12:15], v[156:159], v[36:39], v[12:15]
v_bfe_u32 v44, v0, 4, 1
v_and_b32 v45, 7, v0
v_lshl_add_u32 v44, v44, 3, v45
v_lshlrev_b32 v44, 4, v44
v_bfe_u32 v45, v0, 5, 1
v_mul_u32_u24 v46, 896, v45
s_mul_i32 s3, s48, 1792
v_add3_u32 v56, v44, v46, s3
v_bfe_u32 v44, v0, 3, 1
v_cmp_eq_u32 s[76:77], v44, v45
v_mov_b32 v57, s3
s_waitcnt vmcnt(2)
buffer_load_dwordx4 v[180:183], v1, s[32:35], s65 offen offset:256 nt
s_waitcnt vmcnt(2)
buffer_load_dwordx4 v[184:187], v1, s[32:35], s66 offen offset:0 nt
s_waitcnt vmcnt(2)
buffer_load_dwordx4 v[188:191], v1, s[32:35], s66 offen offset:128 nt
v_and_b32 v32, v24, v40
v_and_b32 v33, v24, v41
v_and_b32 v34, v24, v42
v_and_b32 v35, v24, v43
s_nop 1
v_mfma_f32_16x16x32_bf16 v[4:7], v[160:163], v[32:35], v[4:7]
v_mfma_f32_16x16x32_bf16 v[8:11], v[164:167], v[32:35], v[8:11]
v_mfma_f32_16x16x32_bf16 v[12:15], v[168:171], v[32:35], v[12:15]
v_mov_b32 v47, 0
s_mov_b32 s74, 0
L_spin_3:
ds_read_b32 v46, v47 offset:1732
s_waitcnt lgkmcnt(0)
v_readfirstlane_b32 s3, v46
s_add_u32 s74, s74, 1
s_nop 2
s_cmp_eq_u32 s3, 8
s_cbranch_scc1 L_spind_4
s_cmp_lt_u32 s74, 4000000
s_cbranch_scc0 L_spind_4
s_sleep 1
s_branch L_spin_3
L_spind_4:
ds_read_b32 v44, v47 offset:1736
s_waitcnt lgkmcnt(0)
v_sub_f32 v59, v61, v44
v_mul_f32 v59, 0x3fb8aa3b, v59
v_exp_f32 v59, v59
v_mov_b32 v61, v44
s_waitcnt vmcnt(2)
buffer_load_dwordx4 v[192:195], v1, s[32:35], s66 offen offset:256 nt
s_waitcnt vmcnt(5)
buffer_load_dwordx4 v[196:199], v1, s[32:35], s67 offen offset:0 nt
s_waitcnt vmcnt(5)
buffer_load_dwordx4 v[200:203], v1, s[32:35], s67 offen offset:128 nt
s_lshr_b32 s73, s48, 1
s_cmp_eq_u32 s73, 3
s_cselect_b32 s40, s20, s12
s_cselect_b32 s41, s21, s13
s_mov_b32 s42, 7864320
s_cselect_b32 s42, 1966080, s42
s_cselect_b64 s[74:75], -1, 0
s_and_b32 s41, s41, 0xffff
s_mul_i32 s14, s50, 245760
s_min_u32 s3, s2, 191
s_mul_i32 s3, s3, 10240
s_cmp_eq_u32 s73, 3
s_cselect_b32 s14, s3, s14
s_and_b32 s3, s48, 1
s_mul_i32 s72, s3, 640
s_add_u32 s14, s14, s72
s_mul_i32 s15, s3, 20480
s_lshl_b32 s3, s73, 10
s_add_u32 s15, s15, s3
s_add_u32 s15, s15, 51712
s_mul_i32 s3, s51, 24
s_lshl_b32 s72, s73, 3
s_add_u32 s3, s3, s72
v_lshrrev_b32 v45, 3, v0
v_add_u32 v46, s3, v45
v_and_b32 v44, 0xe0, v46
v_and_b32 v47, 3, v46
v_lshl_add_u32 v44, v47, 3, v44
v_bfe_u32 v47, v46, 2, 3
v_add_u32 v44, v44, v47
v_cndmask_b32 v44, v44, v45, s[74:75]
v_mul_u32_u24 v45, 1280, v44
s_and_b32 s3, s73, 1
s_lshl_b32 s3, s3, 1
v_bfe_u32 v44, v0, 4, 1
v_or_b32 v44, s3, v44
v_lshlrev_b32 v44, 1, v44
v_and_b32 v46, 7, v0
v_xor_b32 v44, v44, v46
v_lshl_add_u32 v2, v44, 4, v45
s_waitcnt vmcnt(5)
buffer_load_dwordx4 v[204:207], v1, s[32:35], s67 offen offset:256 nt
s_waitcnt vmcnt(5)
buffer_load_dwordx4 v[208:211], v1, s[32:35], s68 offen offset:0 nt
s_waitcnt vmcnt(5)
buffer_load_dwordx4 v[212:215], v1, s[32:35], s68 offen offset:128 nt
v_and_b32 v36, v25, v40
v_and_b32 v37, v25, v41
v_and_b32 v38, v25, v42
v_and_b32 v39, v25, v43
s_nop 1
v_mfma_f32_16x16x32_bf16 v[4:7], v[172:175], v[36:39], v[4:7]
v_mfma_f32_16x16x32_bf16 v[8:11], v[176:179], v[36:39], v[8:11]
v_mfma_f32_16x16x32_bf16 v[12:15], v[180:183], v[36:39], v[12:15]
s_waitcnt vmcnt(5)
buffer_load_dwordx4 v[216:219], v1, s[32:35], s68 offen offset:256 nt
s_waitcnt vmcnt(5)
buffer_load_dwordx4 v[220:223], v1, s[32:35], s69 offen offset:0 nt
s_waitcnt vmcnt(5)
buffer_load_dwordx4 v[224:227], v1, s[32:35], s69 offen offset:128 nt
v_and_b32 v32, v26, v40
v_and_b32 v33, v26, v41
v_and_b32 v34, v26, v42
v_and_b32 v35, v26, v43
s_nop 1
v_mfma_f32_16x16x32_bf16 v[4:7], v[184:187], v[32:35], v[4:7]
v_mfma_f32_16x16x32_bf16 v[8:11], v[188:191], v[32:35], v[8:11]
v_mfma_f32_16x16x32_bf16 v[12:15], v[192:195], v[32:35], v[12:15]
v_lshrrev_b32 v45, 4, v0
v_bfe_u32 v46, v0, 2, 2
v_and_b32 v47, 3, v0
v_lshl_add_u32 v48, v45, 3, v46
v_lshlrev_b32 v48, 7, v48
v_lshl_add_u32 v48, v47, 3, v48
v_bfe_u32 v49, v0, 3, 1
v_bfe_u32 v50, v0, 4, 1
v_lshl_or_b32 v49, v50, 1, v49
s_mul_i32 s72, s48, 5
s_add_u32 s3, s72, 0
s_and_b32 s73, s3, 3
s_lshr_b32 s3, s3, 2
s_lshl_b32 s3, s3, 12
v_xor_b32 v50, s73, v49
v_lshl_add_u32 v50, v50, 5, v48
v_add_u32 v80, s3, v50
s_add_u32 s3, s72, 1
s_and_b32 s73, s3, 3
s_lshr_b32 s3, s3, 2
s_lshl_b32 s3, s3, 12
v_xor_b32 v50, s73, v49
v_lshl_add_u32 v50, v50, 5, v48
v_add_u32 v81, s3, v50
s_add_u32 s3, s72, 2
s_and_b32 s73, s3, 3
s_lshr_b32 s3, s3, 2
s_lshl_b32 s3, s3, 12
v_xor_b32 v50, s73, v49
v_lshl_add_u32 v50, v50, 5, v48
v_add_u32 v82, s3, v50
s_add_u32 s3, s72, 3
s_and_b32 s73, s3, 3
s_lshr_b32 s3, s3, 2
s_lshl_b32 s3, s3, 12
v_xor_b32 v50, s73, v49
v_lshl_add_u32 v50, v50, 5, v48
v_add_u32 v83, s3, v50
s_add_u32 s3, s72, 4
s_and_b32 s73, s3, 3
s_lshr_b32 s3, s3, 2
s_lshl_b32 s3, s3, 12
v_xor_b32 v50, s73, v49
v_lshl_add_u32 v50, v50, 5, v48
v_add_u32 v84, s3, v50
v_and_b32 v46, 1, v0
v_lshlrev_b32 v85, 6, v46
v_lshl_add_u32 v85, v45, 4, v85
s_mul_i32 s3, s48, 163840
s_lshl_b32 s72, s2, 7
s_add_u32 s3, s3, s72
s_add_u32 s3, s3, 1179648
v_lshlrev_b32 v86, 6, v46
v_lshl_add_u32 v86, v45, 4, v86
v_bfe_u32 v47, v0, 1, 3
v_lshl_add_u32 v86, v47, 15, v86
v_add_u32 v86, s3, v86
v_cmp_eq_u32 s[4:5], 1, v47
v_cmp_eq_u32 s[6:7], 2, v47
v_cmp_eq_u32 s[8:9], 3, v47
v_cmp_eq_u32 s[12:13], 4, v47
v_and_b32 v46, 7, v0
v_lshrrev_b32 v47, 3, v0
v_mul_u32_u24 v47, 6, v47
v_add_lshl_u32 v47, v47, v46, 4
v_cmp_lt_u32 s[78:79], 5, v46
v_add_u32 v88, 896, v47
v_mov_b32 v46, 768
s_nop 0
v_cndmask_b32 v87, v47, v46, s[78:79]
v_cndmask_b32 v88, v88, v46, s[78:79]
s_lshl_b32 s3, s50, 13
s_lshl_b32 s72, s51, 7
s_add_u32 s72, s72, s3
s_add_u32 s72, s72, 917504
v_lshrrev_b32 v45, 3, v0
v_lshlrev_b32 v45, 10, v45
v_and_b32 v46, 7, v0
v_lshl_add_u32 v45, v46, 4, v45
v_add_u32 v92, s72, v45
s_lshl_b32 s72, s51, 10
s_add_u32 s72, s72, s3
s_add_u32 s72, s72, 917504
v_lshl_add_u32 v93, v0, 4, s72
s_lshl_b32 s3, s51, 3
s_lshl_b64 s[16:17], 0xff, s3
s_waitcnt vmcnt(5)
buffer_load_dwordx4 v[228:231], v1, s[32:35], s69 offen offset:256 nt
s_waitcnt vmcnt(5)
buffer_load_dwordx4 v[232:235], v1, s[32:35], s70 offen offset:0 nt
s_waitcnt vmcnt(5)
buffer_load_dwordx4 v[236:239], v1, s[32:35], s70 offen offset:128 nt
v_and_b32 v36, v27, v40
v_and_b32 v37, v27, v41
v_and_b32 v38, v27, v42
v_and_b32 v39, v27, v43
s_nop 1
v_mfma_f32_16x16x32_bf16 v[4:7], v[196:199], v[36:39], v[4:7]
v_mfma_f32_16x16x32_bf16 v[8:11], v[200:203], v[36:39], v[8:11]
v_mfma_f32_16x16x32_bf16 v[12:15], v[204:207], v[36:39], v[12:15]
s_waitcnt vmcnt(5)
buffer_load_dwordx4 v[240:243], v1, s[32:35], s70 offen offset:256 nt
s_waitcnt vmcnt(5)
buffer_load_dwordx4 v[244:247], v1, s[32:35], s71 offen offset:0 nt
s_waitcnt vmcnt(5)
buffer_load_dwordx4 v[248:251], v1, s[32:35], s71 offen offset:128 nt
v_and_b32 v32, v28, v40
v_and_b32 v33, v28, v41
v_and_b32 v34, v28, v42
v_and_b32 v35, v28, v43
s_nop 1
v_mfma_f32_16x16x32_bf16 v[4:7], v[208:211], v[32:35], v[4:7]
v_mfma_f32_16x16x32_bf16 v[8:11], v[212:215], v[32:35], v[8:11]
v_mfma_f32_16x16x32_bf16 v[12:15], v[216:219], v[32:35], v[12:15]
s_waitcnt vmcnt(5)
buffer_load_dwordx4 v[252:255], v1, s[32:35], s71 offen offset:256 nt
v_and_b32 v36, v29, v40
v_and_b32 v37, v29, v41
v_and_b32 v38, v29, v42
v_and_b32 v39, v29, v43
s_waitcnt vmcnt(6)
s_nop 0
v_mfma_f32_16x16x32_bf16 v[4:7], v[220:223], v[36:39], v[4:7]
v_mfma_f32_16x16x32_bf16 v[8:11], v[224:227], v[36:39], v[8:11]
v_mfma_f32_16x16x32_bf16 v[12:15], v[228:231], v[36:39], v[12:15]
v_and_b32 v32, v30, v40
v_and_b32 v33, v30, v41
v_and_b32 v34, v30, v42
v_and_b32 v35, v30, v43
s_waitcnt vmcnt(3)
s_nop 0
v_mfma_f32_16x16x32_bf16 v[4:7], v[232:235], v[32:35], v[4:7]
v_mfma_f32_16x16x32_bf16 v[8:11], v[236:239], v[32:35], v[8:11]
v_mfma_f32_16x16x32_bf16 v[12:15], v[240:243], v[32:35], v[12:15]
v_and_b32 v36, v31, v40
v_and_b32 v37, v31, v41
v_and_b32 v38, v31, v42
v_and_b32 v39, v31, v43
s_waitcnt vmcnt(0)
s_nop 0
v_mfma_f32_16x16x32_bf16 v[4:7], v[244:247], v[36:39], v[4:7]
v_mfma_f32_16x16x32_bf16 v[8:11], v[248:251], v[36:39], v[8:11]
v_mfma_f32_16x16x32_bf16 v[12:15], v[252:255], v[36:39], v[12:15]
v_mul_f32 v60, v60, v59
v_mul_f32 v60, 0.5, v60
v_mov_b32 v58, v59
s_mov_b32 m0, s15
s_nop 0
buffer_load_dwordx4 v2, s[40:43], s14 offen nt lds
s_add_u32 m0, m0, 4096
s_add_u32 s14, s14, 128
buffer_load_dwordx4 v2, s[40:43], s14 offen nt lds
s_add_u32 m0, m0, 4096
s_add_u32 s14, s14, 128
buffer_load_dwordx4 v2, s[40:43], s14 offen nt lds
s_add_u32 m0, m0, 4096
s_add_u32 s14, s14, 128
buffer_load_dwordx4 v2, s[40:43], s14 offen nt lds
s_add_u32 m0, m0, 4096
s_add_u32 s14, s14, 128
buffer_load_dwordx4 v2, s[40:43], s14 offen nt lds
v_pk_mul_f32 v[4:5], v[4:5], v[58:59]
v_pk_mul_f32 v[6:7], v[6:7], v[58:59]
v_pk_mul_f32 v[8:9], v[8:9], v[58:59]
v_pk_mul_f32 v[10:11], v[10:11], v[58:59]
v_pk_mul_f32 v[12:13], v[12:13], v[58:59]
v_pk_mul_f32 v[14:15], v[14:15], v[58:59]
s_mov_b64 exec, s[76:77]
ds_write_b128 v56, v[4:7] offset:4608
ds_write_b128 v56, v[8:11] offset:4864
ds_write_b128 v56, v[12:15] offset:5120
s_mov_b64 exec, 1
ds_write_b32 v57, v60 offset:5380
s_mov_b64 exec, -1
s_waitcnt lgkmcnt(0)
s_barrier
s_cmp_eq_u32 s48, 4
s_cbranch_scc1 L_pub
s_branch L_nohop1
L_pub:
s_andn2_b64 exec, exec, s[16:17]
buffer_load_dwordx4 v[52:55], v93, s[36:39], 0 offen sc1
s_mov_b64 exec, -1
ds_read_b128 v[96:99], v87 offset:4608
ds_read_b128 v[100:103], v87 offset:6400
ds_read_b128 v[104:107], v87 offset:8192
ds_read_b128 v[108:111], v87 offset:9984
ds_read_b128 v[112:115], v87 offset:11776
ds_read_b128 v[116:119], v87 offset:13568
ds_read_b128 v[120:123], v87 offset:15360
ds_read_b128 v[124:127], v87 offset:17152
ds_read_b128 v[128:131], v88 offset:4608
ds_read_b128 v[132:135], v88 offset:6400
ds_read_b128 v[136:139], v88 offset:8192
ds_read_b128 v[140:143], v88 offset:9984
ds_read_b128 v[144:147], v88 offset:11776
s_mov_b32 s74, 0
s_mov_b32 s76, 0xff00ff00
s_mov_b32 s77, 0xff00ff00
s_waitcnt lgkmcnt(5)
ds_read_b128 v[148:151], v88 offset:13568
ds_read_b128 v[152:155], v88 offset:15360
ds_read_b128 v[156:159], v88 offset:17152
v_pk_add_f32 v[96:97], v[96:97], v[100:101]
v_pk_add_f32 v[98:99], v[98:99], v[102:103]
v_pk_add_f32 v[104:105], v[104:105], v[108:109]
v_pk_add_f32 v[106:107], v[106:107], v[110:111]
v_pk_add_f32 v[112:113], v[112:113], v[116:117]
v_pk_add_f32 v[114:115], v[114:115], v[118:119]
v_pk_add_f32 v[120:121], v[120:121], v[124:125]
v_pk_add_f32 v[122:123], v[122:123], v[126:127]
v_pk_add_f32 v[96:97], v[96:97], v[104:105]
v_pk_add_f32 v[98:99], v[98:99], v[106:107]
v_pk_add_f32 v[112:113], v[112:113], v[120:121]
v_pk_add_f32 v[114:115], v[114:115], v[122:123]
v_pk_add_f32 v[96:97], v[96:97], v[112:113]
v_pk_add_f32 v[98:99], v[98:99], v[114:115]
s_waitcnt lgkmcnt(0)
v_pk_add_f32 v[128:129], v[128:129], v[132:133]
v_pk_add_f32 v[130:131], v[130:131], v[134:135]
v_pk_add_f32 v[136:137], v[136:137], v[140:141]
v_pk_add_f32 v[138:139], v[138:139], v[142:143]
v_pk_add_f32 v[144:145], v[144:145], v[148:149]
v_pk_add_f32 v[146:147], v[146:147], v[150:151]
v_pk_add_f32 v[152:153], v[152:153], v[156:157]
v_pk_add_f32 v[154:155], v[154:155], v[158:159]
v_pk_add_f32 v[128:129], v[128:129], v[136:137]
v_pk_add_f32 v[130:131], v[130:131], v[138:139]
v_pk_add_f32 v[144:145], v[144:145], v[152:153]
v_pk_add_f32 v[146:147], v[146:147], v[154:155]
v_pk_add_f32 v[96:97], v[96:97], v[128:129]
v_pk_add_f32 v[98:99], v[98:99], v[130:131]
v_pk_add_f32 v[96:97], v[96:97], v[144:145]
v_pk_add_f32 v[98:99], v[98:99], v[146:147]
v_cndmask_b32 v96, v96, v61, s[78:79]
v_bfi_b32 v48, s55, v96, v63
v_bfi_b32 v49, s55, v97, v63
v_bfi_b32 v50, s55, v98, v63
v_bfi_b32 v51, s55, v99, v63
s_cmp_eq_u32 s11, 1
s_cbranch_scc1 L_pubfast
buffer_store_dwordx4 v[48:51], v92, s[36:39], 0 offen sc1
s_branch L_pubdone
L_pubfast:
buffer_store_dwordx4 v[48:51], v92, s[36:39], 0 offen
L_pubdone:
s_waitcnt vmcnt(1)
v_cndmask_b32 v52, v52, v48, s[16:17]
v_cndmask_b32 v53, v53, v49, s[16:17]
v_cndmask_b32 v54, v54, v50, s[16:17]
v_cndmask_b32 v55, v55, v51, s[16:17]
L_opoll:
v_xor_b32 v52, v52, v63
v_xor_b32 v53, v53, v63
v_xor_b32 v54, v54, v63
v_xor_b32 v55, v55, v63
v_or3_b32 v47, v52, v53, v54
v_or_b32 v47, v47, v55
v_and_b32 v47, 0x3ff, v47
v_cmp_ne_u32 vcc, 0, v47
s_add_u32 s74, s74, 1
s_nop 3
s_cmp_eq_u64 vcc, 0
s_cbranch_scc1 L_ook
s_mov_b64 exec, vcc
s_cmp_lt_u32 s74, 200000
s_cbranch_scc0 L_oto
buffer_load_dwordx4 v[52:55], v93, s[36:39], 0 offen sc1
s_waitcnt vmcnt(0)
s_branch L_opoll
L_oto:
s_mov_b64 exec, -1
v_mov_b32 v56, 0x103
v_mov_b32 v57, 8
global_store_dword v57, v56, s[24:25]
L_ook:
s_mov_b64 exec, -1
v_mov_b32_dpp v105, v52 row_newbcast:6 row_mask:0xf bank_mask:0xf
v_mov_b32_dpp v106, v52 row_newbcast:14 row_mask:0xf bank_mask:0xf
v_mov_b32_dpp v107, v53 row_newbcast:6 row_mask:0xf bank_mask:0xf
v_mov_b32_dpp v108, v53 row_newbcast:14 row_mask:0xf bank_mask:0xf
v_cndmask_b32 v105, v105, v106, s[76:77]
v_cndmask_b32 v106, v107, v108, s[76:77]
v_mov_b32 v107, v105
s_nop 1
v_max_f32_dpp v107, v107, v107 row_ror:8 row_mask:0xf bank_mask:0xf
v_mov_b32 v108, v107
s_nop 1
v_permlane16_swap_b32 v107, v108
s_nop 0
v_max_f32 v107, v107, v108
v_sub_f32 v105, v105, v107
v_mul_f32 v105, 0x3fb8aa3b, v105
v_exp_f32 v105, v105
s_nop 0
v_mul_f32 v106, v106, v105
v_mul_f32 v52, v52, v105
v_mul_f32 v53, v53, v105
v_mul_f32 v54, v54, v105
v_mul_f32 v55, v55, v105
v_add_f32_dpp v106, v106, v106 row_ror:8 row_mask:0xf bank_mask:0xf
v_add_f32_dpp v52, v52, v52 row_ror:8 row_mask:0xf bank_mask:0xf
v_add_f32_dpp v53, v53, v53 row_ror:8 row_mask:0xf bank_mask:0xf
v_add_f32_dpp v54, v54, v54 row_ror:8 row_mask:0xf bank_mask:0xf
v_add_f32_dpp v55, v55, v55 row_ror:8 row_mask:0xf bank_mask:0xf
v_mov_b32 v109, v106
v_mov_b32 v110, v52
v_mov_b32 v111, v53
v_mov_b32 v112, v54
v_mov_b32 v113, v55
v_permlane16_swap_b32 v106, v109
v_permlane16_swap_b32 v52, v110
v_permlane16_swap_b32 v53, v111
v_permlane16_swap_b32 v54, v112
v_permlane16_swap_b32 v55, v113
s_nop 0
v_add_f32 v106, v106, v109
v_add_f32 v52, v52, v110
v_add_f32 v53, v53, v111
v_add_f32 v54, v54, v112
v_add_f32 v55, v55, v113
v_rcp_f32 v106, v106
v_lshrrev_b32 v109, 5, v0
v_lshlrev_b32 v109, 6, v109
v_and_b32 v110, 7, v0
v_lshl_add_u32 v109, v110, 3, v109
v_mul_f32 v52, v52, v106
v_mul_f32 v53, v53, v106
v_mul_f32 v54, v54, v106
v_mul_f32 v55, v55, v106
v_cvt_pk_bf16_f32 v52, v52, v53
v_cvt_pk_bf16_f32 v53, v54, v55
s_mov_b32 exec_lo, 0x3f3f3f3f
s_mov_b32 exec_hi, 0x3f3f3f3f
ds_write_b64 v109, v[52:53] offset:1536
s_mov_b64 exec, -1
s_branch L_nohop1w
L_nohop1:
s_waitcnt vmcnt(0)
L_nohop1w:
s_waitcnt lgkmcnt(0)
s_barrier
ds_read_b64_tr_b16 v[160:161], v80 offset:51712
ds_read_b64_tr_b16 v[162:163], v80 offset:52224
ds_read_b64_tr_b16 v[164:165], v81 offset:51712
ds_read_b64_tr_b16 v[166:167], v81 offset:52224
ds_read_b64_tr_b16 v[168:169], v82 offset:51712
ds_read_b64_tr_b16 v[170:171], v82 offset:52224
ds_read_b64_tr_b16 v[172:173], v83 offset:51712
ds_read_b64_tr_b16 v[174:175], v83 offset:52224
ds_read_b64_tr_b16 v[176:177], v84 offset:51712
ds_read_b64_tr_b16 v[178:179], v84 offset:52224
ds_read_b128 v[88:91], v85 offset:1536
s_waitcnt lgkmcnt(0)
v_mfma_f32_16x16x32_bf16 v[112:115], v[160:163], v[88:91], 0
v_mfma_f32_16x16x32_bf16 v[116:119], v[164:167], v[88:91], 0
v_mfma_f32_16x16x32_bf16 v[120:123], v[168:171], v[88:91], 0
v_mfma_f32_16x16x32_bf16 v[124:127], v[172:175], v[88:91], 0
v_mfma_f32_16x16x32_bf16 v[128:131], v[176:179], v[88:91], 0
s_nop 4
v_cndmask_b32 v112, v112, v116, s[4:5]
v_cndmask_b32 v113, v113, v117, s[4:5]
v_cndmask_b32 v114, v114, v118, s[4:5]
v_cndmask_b32 v115, v115, v119, s[4:5]
v_cndmask_b32 v112, v112, v120, s[6:7]
v_cndmask_b32 v113, v113, v121, s[6:7]
v_cndmask_b32 v114, v114, v122, s[6:7]
v_cndmask_b32 v115, v115, v123, s[6:7]
v_cndmask_b32 v112, v112, v124, s[8:9]
v_cndmask_b32 v113, v113, v125, s[8:9]
v_cndmask_b32 v114, v114, v126, s[8:9]
v_cndmask_b32 v115, v115, v127, s[8:9]
v_cndmask_b32 v112, v112, v128, s[12:13]
v_cndmask_b32 v113, v113, v129, s[12:13]
v_cndmask_b32 v114, v114, v130, s[12:13]
v_cndmask_b32 v115, v115, v131, s[12:13]
v_bfi_b32 v112, s55, v112, v63
v_bfi_b32 v113, s55, v113, v63
v_bfi_b32 v114, s55, v114, v63
v_bfi_b32 v115, s55, v115, v63
s_mov_b32 exec_lo, 0x03ff03ff
s_mov_b32 exec_hi, 0x03ff03ff
buffer_store_dwordx4 v[112:115], v86, s[36:39], 0 offen sc1
s_mov_b64 exec, -1
s_cmp_ge_u32 s2, 40
s_cbranch_scc1 L_fin
s_lshl_b32 s3, s2, 15
s_lshl_b32 s72, s48, 12
s_add_u32 s3, s3, s72
s_add_u32 s3, s3, 1179648
v_lshl_add_u32 v44, v0, 4, s3
s_lshl_b32 s72, s2, 5
v_and_b32 v45, 7, v0
v_lshl_add_u32 v45, v45, 2, s72
v_bfe_u32 v46, v0, 3, 1
v_mul_u32_u24 v46, 1280, v46
v_add_u32 v45, v45, v46
buffer_load_dword v60, v45, s[44:47], 0 offen
s_mov_b32 s74, 0
L_ypoll:
buffer_load_dwordx4 v[132:135], v44, s[36:39], 0 offen offset:0 sc1
buffer_load_dwordx4 v[136:139], v44, s[36:39], 0 offen offset:1024 sc1
buffer_load_dwordx4 v[140:143], v44, s[36:39], 0 offen offset:2048 sc1
buffer_load_dwordx4 v[144:147], v44, s[36:39], 0 offen offset:3072 sc1
s_waitcnt vmcnt(0)
v_xor_b32 v132, v132, v63
v_xor_b32 v133, v133, v63
v_xor_b32 v134, v134, v63
v_xor_b32 v135, v135, v63
v_xor_b32 v136, v136, v63
v_xor_b32 v137, v137, v63
v_xor_b32 v138, v138, v63
v_xor_b32 v139, v139, v63
v_xor_b32 v140, v140, v63
v_xor_b32 v141, v141, v63
v_xor_b32 v142, v142, v63
v_xor_b32 v143, v143, v63
v_xor_b32 v144, v144, v63
v_xor_b32 v145, v145, v63
v_xor_b32 v146, v146, v63
v_xor_b32 v147, v147, v63
v_or3_b32 v47, v132, v133, v134
v_or3_b32 v47, v47, v135, v136
v_or3_b32 v47, v47, v137, v138
v_or3_b32 v47, v47, v139, v140
v_or3_b32 v47, v47, v141, v142
v_or3_b32 v47, v47, v143, v144
v_or3_b32 v47, v47, v145, v146
v_or_b32 v47, v47, v147
v_and_b32 v47, 0x3ff, v47
v_cmp_ne_u32 vcc, 0, v47
s_add_u32 s74, s74, 1
s_nop 3
s_andn2_b64 exec, exec, vcc
s_cbranch_execz L_yn_6
v_add_f32 v132, v132, v136
v_add_f32 v133, v133, v137
v_add_f32 v134, v134, v138
v_add_f32 v135, v135, v139
v_add_f32 v140, v140, v144
v_add_f32 v141, v141, v145
v_add_f32 v142, v142, v146
v_add_f32 v143, v143, v147
v_add_f32 v100, v132, v140
v_add_f32 v101, v133, v141
v_add_f32 v102, v134, v142
v_add_f32 v103, v135, v143
L_yn_6:
s_cmp_eq_u64 vcc, 0
s_cbranch_scc1 L_yok
s_mov_b64 exec, vcc
s_cmp_lt_u32 s74, 200000
s_cbranch_scc1 L_ypoll
s_mov_b64 exec, -1
v_mov_b32 v56, 0x104
v_mov_b32 v57, 12
global_store_dword v57, v56, s[24:25]
L_yok:
s_mov_b64 exec, -1
v_add_f32_dpp v100, v100, v100 row_ror:8 row_mask:0xf bank_mask:0xf
v_add_f32_dpp v101, v101, v101 row_ror:8 row_mask:0xf bank_mask:0xf
v_add_f32_dpp v102, v102, v102 row_ror:8 row_mask:0xf bank_mask:0xf
v_add_f32_dpp v103, v103, v103 row_ror:8 row_mask:0xf bank_mask:0xf
s_lshl_b32 s3, s48, 7
v_and_b32 v46, 7, v0
v_lshlrev_b32 v46, 4, v46
v_permlane16_swap_b32 v100, v101
v_permlane16_swap_b32 v102, v103
v_lshrrev_b32 v47, 4, v0
v_add_f32 v100, v100, v101
v_add_f32 v102, v102, v103
v_lshl_add_u32 v46, v47, 2, v46
v_add_u32 v46, s3, v46
v_permlane32_swap_b32 v100, v102
s_nop 1
v_add_f32 v100, v100, v102
s_mov_b32 exec_lo, 0x00ff00ff
s_mov_b32 exec_hi, 0x00ff00ff
ds_write_b32 v46, v100 offset:512
s_mov_b64 exec, -1
s_waitcnt lgkmcnt(0)
s_barrier
s_cmp_eq_u32 s48, 0
s_cbranch_scc0 L_fin
v_lshlrev_b32 v46, 3, v0
ds_read_b64 v[100:101], v46 offset:512
ds_read_b64 v[102:103], v46 offset:1024
s_mov_b32 s44, s22
s_and_b32 s45, s23, 0xffff
s_waitcnt lgkmcnt(0)
v_add_f32 v100, v100, v102
v_add_f32 v101, v101, v103
v_mov_b32 v104, v100
v_mov_b32 v105, v101
s_nop 1
v_permlane16_swap_b32 v100, v104
v_permlane16_swap_b32 v101, v105
s_nop 0
v_add_f32 v100, v100, v104
v_add_f32 v101, v101, v105
v_mov_b32 v104, v100
v_mov_b32 v105, v101
s_nop 1
v_permlane32_swap_b32 v100, v104
v_permlane32_swap_b32 v101, v105
s_nop 0
v_add_f32 v100, v100, v104
v_add_f32 v101, v101, v105
v_lshlrev_b32 v104, 16, v60
v_and_b32 v105, 0xffff0000, v60
v_add_f32 v100, v100, v104
v_add_f32 v101, v101, v105
v_cvt_pk_bf16_f32 v100, v100, v101
s_mov_b64 exec, 0xffff
buffer_store_dword v100, v45, s[44:47], 0 offen
s_cmp_eq_u32 s2, 0
s_cbranch_scc0 L_fin
v_mov_b32 v46, s54
v_mov_b32 v47, 0
s_mov_b64 exec, 1
buffer_store_dword v46, v47, s[36:39], 0 offen
L_fin:
s_mov_b64 exec, -1
L_end:
s_endpgm
.section .rodata,"a"
.p2align 6
.amdhsa_kernel parallel_sum__mha_block_cached__swiglu_ffn__decode_kernel
.amdhsa_next_free_vgpr 256
.amdhsa_next_free_sgpr 102
.amdhsa_accum_offset 256
.amdhsa_group_segment_fixed_size 0
.amdhsa_kernarg_size 96
.amdhsa_user_sgpr_count 2
.amdhsa_user_sgpr_kernarg_segment_ptr 1
.amdhsa_system_sgpr_workgroup_id_x 1
.amdhsa_float_denorm_mode_32 3
.end_amdhsa_kernel
```
